```python
import torch

def _softmax(x, axis=-1):
    return torch.softmax(x, dim=axis)
def _gelu(x):
    return torch.nn.functional.gelu(x, approximate="tanh")
def _silu(x):
    return torch.nn.functional.silu(x)
def _sigmoid(x):
    return torch.sigmoid(x)
def _layernorm(x, axis=-1, eps=1e-5):
    m = x.mean(dim=axis, keepdim=True)
    v = x.var(dim=axis, keepdim=True, unbiased=False)
    return (x - m) / torch.sqrt(v + eps)
def _scatter_add(tgt, idx, src, axis=0):
    return tgt.clone().index_add_(axis, idx, src)
def _segment_sum(src, seg, n):
    out = torch.zeros((n,) + src.shape[1:], dtype=src.dtype)
    return out.index_add_(0, seg, src)
def _pad(x, pw):
    flat = tuple(v for pair in reversed(pw) for v in pair)
    return torch.nn.functional.pad(x, flat)

kernel_name = 'standalone__modern_conv_block_slak__vision'

def setup_inputs():

    _w = (lambda a: (lambda t: t.to(torch.bfloat16) if t.is_floating_point() else t)(torch.as_tensor(a)))
    H = W = 224
    C = 96
    K = 3
    return {
        "x": _w((lambda *s: torch.randn(*s, dtype=torch.bfloat16) * 0.05)(1, H, W, C)),
        "dw": _w((lambda *s: torch.randn(*s, dtype=torch.bfloat16) * 0.05)(K, K, C)),
        "w1": _w((lambda *s: torch.randn(*s, dtype=torch.bfloat16) * 0.05)(C, 4 * C)),
        "w2": _w((lambda *s: torch.randn(*s, dtype=torch.bfloat16) * 0.05)(4 * C, C)),
        "grn_g": _w((lambda *s: torch.randn(*s, dtype=torch.bfloat16) * 0.05)(4 * C)),
        "grn_b": _w((lambda *s: torch.randn(*s, dtype=torch.bfloat16) * 0.05)(4 * C)),
    }

def reference(x, dw, w1, w2, grn_g, grn_b):
    B, H, W, C = x.shape
    K = dw.shape[0]
    pad = K // 2
    xp = _pad(x, ((0,0),(pad,pad),(pad,pad),(0,0)))
    out = torch.zeros_like(x)
    for i in range(K):
        for j in range(K):
            out = out + xp[:, i:i+H, j:j+W, :] * dw[i, j][None, None, None, :]
    h = _layernorm(out, axis=-1)
    h = _gelu(h @ w1)
    gx = torch.sqrt((h * h).sum(axis=(1, 2), keepdims=True) + 1e-6)
    nx = gx / (gx.mean(axis=-1, keepdims=True) + 1e-6)
    h = grn_g[None, None, None, :] * (h * nx) + grn_b[None, None, None, :] + h
    return x + h @ w2
```

```asm
; @launch grid=(256,1,1) block=(512,1,1) lds=163840
.amdgcn_target "amdgcn-amd-amdhsa--gfx950"
.text
.globl standalone__modern_conv_block_slak__vision_kernel
.p2align 8
.type standalone__modern_conv_block_slak__vision_kernel,@function
standalone__modern_conv_block_slak__vision_kernel:
    s_cmp_ge_u32 s2, 256
    s_cbranch_scc1 L_exit
    s_load_dwordx2 s[4:5], s[0:1], 0
    s_load_dwordx2 s[12:13], s[0:1], 8
    v_lshrrev_b32 v12, 6, v0
    v_and_b32 v11, 63, v0
    s_and_b32 s48, s2, 7
    v_readfirstlane_b32 s44, v12
    s_lshr_b32 s49, s2, 3
    s_cmp_lg_u32 s44, 3
    s_cbranch_scc1 L_nopf
    s_getpc_b64 s[54:55]
L_pc:
    s_sub_u32 s54, s54, L_pc-standalone__modern_conv_block_slak__vision_kernel
    s_subb_u32 s55, s55, 0
    s_mul_i32 s57, s49, (L_exit-standalone__modern_conv_block_slak__vision_kernel+4095)/4096*128
    v_lshlrev_b32 v15, 7, v11
    v_add_u32 v16, s57, v15
    v_min_u32 v16, L_exit-standalone__modern_conv_block_slak__vision_kernel, v16
    v_mov_b32 v17, s55
    v_add_co_u32 v16, vcc, s54, v16
    s_nop 1
    v_addc_co_u32 v17, vcc, 0, v17, vcc
    s_mov_b64 exec, 0x3ff
    global_load_dword v10, v[16:17], off
    s_mov_b64 exec, -1
L_nopf:
    s_and_b32 s51, s48, 1
    s_lshl_b32 s51, s51, 3
    s_and_b32 s52, s49, 7
    s_add_u32 s51, s51, s52
    s_mul_i32 s47, s51, 14
    s_sub_u32 s47, s47, 1
    s_lshr_b32 s50, s48, 1
    s_lshl_b32 s50, s50, 2
    s_lshr_b32 s52, s49, 3
    s_add_u32 s50, s50, s52
    s_mul_i32 s46, s50, 14
    s_sub_u32 s46, s46, 1
    s_and_b32 s45, s44, 3
    v_lshrrev_b32 v121, 4, v11
    v_lshlrev_b32 v2, 4, v11
    v_lshrrev_b32 v14, 2, v11
    v_and_b32 v15, 3, v11
    v_xor_b32 v15, v15, v121
    v_add_u32 v14, s47, v14
    v_cmp_gt_u32 vcc, 224, v14
    v_mul_u32_u24 v14, 192, v14
    v_mov_b32 v13, 2130706432
    v_lshl_add_u32 v14, v15, 4, v14
    v_lshlrev_b32 v130, 1, v11
    s_mul_i32 s52, s45, 576
    s_mov_b32 s14, 1728
    s_mov_b32 s15, 0x20000
    s_mov_b32 s7, 0x20000
    s_add_u32 s53, s45, s46
    s_mul_i32 s51, s45, 3072
    v_cndmask_b32 v12, v13, v14, vcc
    s_cmp_ge_u32 s44, 3
    s_waitcnt lgkmcnt(0)
    s_cbranch_scc1 L_nodw
    buffer_load_ushort v132, v130, s[12:15], s52 offen offset:0
    buffer_load_ushort v133, v130, s[12:15], s52 offen offset:192
    buffer_load_ushort v134, v130, s[12:15], s52 offen offset:384
    s_mov_b32 exec_hi, 0
    buffer_load_ushort v135, v130, s[12:15], s52 offen offset:128
    buffer_load_ushort v136, v130, s[12:15], s52 offen offset:320
    buffer_load_ushort v137, v130, s[12:15], s52 offen offset:512
    s_mov_b64 exec, -1
    s_branch L_a0
L_nodw:
    s_cmp_eq_u32 s44, 3
    s_cbranch_scc1 L_a3
    s_mul_i32 s50, s53, 43008
    s_cmp_lt_u32 s53, 224
    s_cselect_b32 s50, s50, 0
    s_cselect_b32 s6, 9633792, 0
    s_add_u32 s53, s53, 4
    s_add_u32 m0, s51, 0
    s_nop 0
    buffer_load_dwordx4 v12, s[4:7], s50 offen offset:0  lds
    s_add_u32 m0, s51, 960
    s_nop 0
    buffer_load_dwordx4 v12, s[4:7], s50 offen offset:64  lds
    s_add_u32 m0, s51, 1920
    s_nop 0
    buffer_load_dwordx4 v12, s[4:7], s50 offen offset:128  lds
    s_mul_i32 s50, s53, 43008
    s_cmp_lt_u32 s53, 224
    s_cselect_b32 s50, s50, 0
    s_cselect_b32 s6, 9633792, 0
    s_add_u32 s53, s53, 4
    s_add_u32 m0, s51, 12288
    s_nop 0
    buffer_load_dwordx4 v12, s[4:7], s50 offen offset:0  lds
    s_add_u32 m0, s51, 13248
    s_nop 0
    buffer_load_dwordx4 v12, s[4:7], s50 offen offset:64  lds
    s_add_u32 m0, s51, 14208
    s_nop 0
    buffer_load_dwordx4 v12, s[4:7], s50 offen offset:128  lds
    s_mul_i32 s50, s53, 43008
    s_cmp_lt_u32 s53, 224
    s_cselect_b32 s50, s50, 0
    s_cselect_b32 s6, 9633792, 0
    s_add_u32 s53, s53, 4
    s_add_u32 m0, s51, 24576
    s_nop 0
    buffer_load_dwordx4 v12, s[4:7], s50 offen offset:0  lds
    s_add_u32 m0, s51, 25536
    s_nop 0
    buffer_load_dwordx4 v12, s[4:7], s50 offen offset:64  lds
    s_add_u32 m0, s51, 26496
    s_nop 0
    buffer_load_dwordx4 v12, s[4:7], s50 offen offset:128  lds
    s_mul_i32 s50, s53, 43008
    s_cmp_lt_u32 s53, 224
    s_cselect_b32 s50, s50, 0
    s_cselect_b32 s6, 9633792, 0
    s_add_u32 s53, s53, 4
    s_add_u32 m0, s51, 36864
    s_nop 0
    buffer_load_dwordx4 v12, s[4:7], s50 offen offset:0  lds
    s_add_u32 m0, s51, 37824
    s_nop 0
    buffer_load_dwordx4 v12, s[4:7], s50 offen offset:64  lds
    s_add_u32 m0, s51, 38784
    s_nop 0
    buffer_load_dwordx4 v12, s[4:7], s50 offen offset:128  lds
    s_load_dwordx2 s[16:17], s[0:1], 16
    s_load_dwordx2 s[8:9], s[0:1], 0
    s_load_dwordx2 s[20:21], s[0:1], 24
    s_load_dwordx2 s[24:25], s[0:1], 32
    s_load_dwordx2 s[28:29], s[0:1], 40
    s_load_dwordx2 s[32:33], s[0:1], 48
    s_load_dwordx2 s[36:37], s[0:1], 56
    s_load_dwordx2 s[40:41], s[0:1], 64
    s_mov_b32 s18, 73728
    s_mov_b32 s19, 0x20000
    s_mov_b32 s10, 9633792
    s_mov_b32 s11, 0x20000
    s_mov_b32 s22, 73728
    s_mov_b32 s23, 0x20000
    s_mov_b32 s26, 768
    s_mov_b32 s27, 0x20000
    s_mov_b32 s30, 768
    s_mov_b32 s31, 0x20000
    s_mov_b32 s34, 9633792
    s_mov_b32 s35, 0x20000
    s_mov_b32 s38, 256
    s_mov_b32 s39, 0x20000
    s_mov_b32 s42, 268435456
    s_mov_b32 s43, 0x20000
    s_add_u32 s68, s46, 1
    s_mul_i32 s68, s68, 224
    s_add_u32 s68, s68, s47
    s_add_u32 s68, s68, 1
    s_mul_i32 s68, s68, 192
    s_and_b32 s67, s49, 15
    v_and_b32 v120, 15, v11
    s_branch L_b1
L_a3:
    s_load_dwordx2 s[16:17], s[0:1], 16
    s_load_dwordx2 s[8:9], s[0:1], 0
    s_load_dwordx2 s[20:21], s[0:1], 24
    s_load_dwordx2 s[24:25], s[0:1], 32
    s_load_dwordx2 s[28:29], s[0:1], 40
    s_load_dwordx2 s[32:33], s[0:1], 48
    s_load_dwordx2 s[36:37], s[0:1], 56
    s_load_dwordx2 s[40:41], s[0:1], 64
    s_mov_b32 s18, 73728
    s_mov_b32 s19, 0x20000
    s_mov_b32 s10, 9633792
    s_mov_b32 s11, 0x20000
    s_mov_b32 s22, 73728
    s_mov_b32 s23, 0x20000
    s_mov_b32 s26, 768
    s_mov_b32 s27, 0x20000
    s_mov_b32 s30, 768
    s_mov_b32 s31, 0x20000
    s_mov_b32 s34, 9633792
    s_mov_b32 s35, 0x20000
    s_mov_b32 s38, 256
    s_mov_b32 s39, 0x20000
    s_mov_b32 s42, 268435456
    s_mov_b32 s43, 0x20000
    s_add_u32 s68, s46, 1
    s_mul_i32 s68, s68, 224
    s_add_u32 s68, s68, s47
    s_add_u32 s68, s68, 1
    s_mul_i32 s68, s68, 192
    s_and_b32 s67, s49, 15
    v_and_b32 v120, 15, v11
    s_waitcnt lgkmcnt(0)
    s_lshr_b32 s57, s2, 3
    s_mul_i32 s57, s57, 2304
    v_lshlrev_b32 v15, 3, v2
    v_add_u32 v16, s57, v15
    v_mov_b32 v17, 2130706432
    v_cmp_gt_u32 vcc, 288, v2
    s_nop 1
    v_cndmask_b32 v16, v17, v16, vcc
    buffer_load_dword v10, v16, s[16:19], 0 offen
    s_branch L_a1
L_a0:
    s_load_dwordx2 s[16:17], s[0:1], 16
    s_load_dwordx2 s[8:9], s[0:1], 0
    s_load_dwordx2 s[20:21], s[0:1], 24
    s_load_dwordx2 s[24:25], s[0:1], 32
    s_load_dwordx2 s[28:29], s[0:1], 40
    s_load_dwordx2 s[32:33], s[0:1], 48
    s_load_dwordx2 s[36:37], s[0:1], 56
    s_load_dwordx2 s[40:41], s[0:1], 64
    s_mov_b32 s18, 73728
    s_mov_b32 s19, 0x20000
    s_mov_b32 s10, 9633792
    s_mov_b32 s11, 0x20000
    s_mov_b32 s22, 73728
    s_mov_b32 s23, 0x20000
    s_mov_b32 s26, 768
    s_mov_b32 s27, 0x20000
    s_mov_b32 s30, 768
    s_mov_b32 s31, 0x20000
    s_mov_b32 s34, 9633792
    s_mov_b32 s35, 0x20000
    s_mov_b32 s38, 256
    s_mov_b32 s39, 0x20000
    s_mov_b32 s42, 268435456
    s_mov_b32 s43, 0x20000
    s_add_u32 s68, s46, 1
    s_mul_i32 s68, s68, 224
    s_add_u32 s68, s68, s47
    s_add_u32 s68, s68, 1
    s_mul_i32 s68, s68, 192
    s_and_b32 s67, s49, 15
    v_and_b32 v120, 15, v11
    v_mov_b64 v[140:141], 0
    v_mov_b64 v[142:143], 0
    s_mul_i32 s48, s45, 6144
    s_add_u32 s48, s48, 135168
    v_add_u32 v14, s48, v2
    ds_write_b128 v14, v[140:143] offset:0
    ds_write_b128 v14, v[140:143] offset:1024
    ds_write_b128 v14, v[140:143] offset:2048
    ds_write_b128 v14, v[140:143] offset:3072
    ds_write_b128 v14, v[140:143] offset:4096
    ds_write_b128 v14, v[140:143] offset:5120
    v_and_b32 v15, 15, v11
    v_lshrrev_b32 v16, 3, v15
    v_lshl_add_u32 v16, v16, 5, v15
    v_lshlrev_b32 v16, 4, v16
    v_lshl_add_u32 v16, v121, 10, v16
    v_and_b32 v15, 4, v15
    v_add3_u32 v131, v16, v15, s48
L_a1:
    v_min_u32 v122, 2, v121
    v_add_u32 v122, v122, v120
    v_bfe_u32 v123, v122, 2, 2
    v_lshlrev_b32 v122, 6, v122
    s_mul_i32 s51, s44, 12288
    v_add_u32 v122, s51, v122
    v_xor_b32 v124, 0, v123
    v_lshl_add_u32 v154, v124, 4, v122
    v_xor_b32 v124, 1, v123
    v_lshl_add_u32 v155, v124, 4, v122
    v_xor_b32 v124, 2, v123
    v_lshl_add_u32 v156, v124, 4, v122
    v_xor_b32 v124, 3, v123
    v_lshl_add_u32 v157, v124, 4, v122
    v_and_b32 v124, 3, v120
    v_mul_u32_u24 v158, 0x1111, v124
    v_lshrrev_b32 v125, 2, v120
    v_lshl_add_u32 v124, v125, 3, v124
    v_and_b32 v125, 4, v120
    v_add_u32 v124, v124, v125
    v_lshlrev_b32 v124, 4, v124
    v_lshl_add_u32 v124, v121, 9, v124
    s_add_u32 s48, s51, 6144
    s_mul_i32 s50, s44, 6144
    s_add_u32 s50, s50, 116736
    s_cmp_eq_u32 s44, 0
    s_cselect_b32 s48, 0, s48
    s_cselect_b32 s50, 6144, s50
    v_add_u32 v159, s48, v124
    v_add_u32 v9, s50, v124
    v_add_u32 v16, 135168, v2
    s_mov_b32 s60, 1084043516
    s_mov_b32 s61, 1084043516
    s_mov_b32 s65, 0x00003f80
    s_mov_b32 s66, 0x3f800000
    v_lshlrev_b32 v3, 2, v11
    v_and_b32 v125, 8, v11
    v_lshlrev_b32 v125, 3, v125
    v_xor_b32 v4, v125, v2
    v_lshrrev_b32 v125, 2, v120
    v_lshrrev_b32 v122, 5, v11
    v_lshl_add_u32 v125, v122, 2, v125
    v_and_b32 v124, 1, v121
    v_lshlrev_b32 v124, 5, v124
    v_lshl_add_u32 v125, v125, 6, v124
    v_and_b32 v124, 3, v11
    v_lshlrev_b32 v124, 3, v124
    s_mul_i32 s48, s45, 18432
    s_add_u32 s48, s48, 49152
    v_add3_u32 v12, v125, v124, s48
    v_and_b32 v123, 31, v11
    s_mul_i32 s48, s45, 96
    v_add_u32 v124, s48, v123
    v_bfe_u32 v125, v123, 2, 1
    v_xor_b32 v125, v125, v122
    v_lshlrev_b32 v125, 4, v125
    v_lshl_add_u32 v125, v124, 5, v125
    v_add_u32 v5, 122880, v125
    v_add_u32 v6, 49152, v125
    s_lshl_b32 s48, s45, 9
    s_add_u32 s48, s48, 159744
    v_lshlrev_b32 v123, 4, v123
    v_lshlrev_b32 v122, 2, v122
    v_add3_u32 v7, v122, v123, s48
    s_mul_i32 s48, s45, 12288
    s_add_u32 s73, s48, 36864
    s_add_u32 s74, s48, 73728
    s_add_u32 s62, s48, 12288
    s_cmp_eq_u32 s45, 0
    s_cselect_b32 s73, 135168, s73
    s_cselect_b32 s62, 0, s62
    s_cselect_b32 s53, 0, 43
    s_cselect_b32 s54, 0, 8
    s_cselect_b32 s55, 12, 0
    s_cmp_eq_u32 s45, 2
    s_cselect_b32 s52, 8, 0
    s_cmp_eq_u32 s45, 3
    s_cselect_b32 s73, 147456, s73
    s_cselect_b32 s62, 122880, s62
    s_cselect_b32 s55, 8, s55
    v_and_b32 v122, 7, v11
    v_bfe_u32 v123, v11, 3, 1
    v_lshlrev_b32 v121, 4, v121
    v_add_u32 v121, s68, v121
    v_add_u32 v124, s52, v122
    v_mul_u32_u24 v125, s53, v124
    v_lshrrev_b32 v125, 8, v125
    v_mul_u32_u24 v126, 6, v125
    v_sub_u32 v124, v124, v126
    v_add_u32 v124, s54, v124
    v_and_b32 v126, 1, v125
    v_lshl_add_u32 v126, v126, 2, v123
    v_and_b32 v125, 2, v125
    v_add3_u32 v125, v125, v126, s55
    v_mul_u32_u24 v125, 43008, v125
    v_mul_u32_u24 v124, 192, v124
    v_add3_u32 v1, v124, v125, v121
    s_lshl_b32 s48, s45, 1
    s_cmp_eq_u32 s45, 0
    s_cselect_b32 s55, 10, 6
    s_cmp_ge_u32 s45, 2
    s_cselect_b32 s53, 43, 0
    s_cselect_b32 s54, 8, 0
    s_cselect_b32 s55, 0, s55
    s_cselect_b32 s52, 16, 0
    s_cmp_eq_u32 s45, 3
    s_cselect_b32 s52, 8, s52
    s_cselect_b32 s55, 8, s55
    s_cselect_b32 s48, 8, s48
    v_add_u32 v124, s52, v122
    v_mul_u32_u24 v125, s53, v124
    v_lshrrev_b32 v125, 8, v125
    v_mul_u32_u24 v126, 6, v125
    v_sub_u32 v124, v124, v126
    v_add_u32 v124, s54, v124
    v_and_b32 v126, 1, v125
    v_lshl_add_u32 v126, v126, 2, v123
    v_and_b32 v125, 2, v125
    v_add3_u32 v125, v125, v126, s55
    v_mul_u32_u24 v125, 43008, v125
    v_mul_u32_u24 v124, 192, v124
    v_add3_u32 v8, v124, v125, v121
    v_add_u32 v123, s48, v123
    v_mul_u32_u24 v123, 43008, v123
    v_mul_u32_u24 v122, 192, v122
    v_add3_u32 v0, v122, v123, v121
    v_mov_b64 v[18:19], 0
    v_mov_b64 v[20:21], 0
    v_mov_b64 v[22:23], 0
    v_mov_b64 v[24:25], 0
    v_mov_b64 v[26:27], 0
    v_mov_b64 v[28:29], 0
    v_mov_b64 v[30:31], 0
    v_mov_b64 v[32:33], 0
    v_mov_b64 v[34:35], 0
    v_mov_b64 v[36:37], 0
    v_mov_b64 v[38:39], 0
    v_mov_b64 v[40:41], 0
    v_mov_b64 v[42:43], 0
    v_mov_b64 v[44:45], 0
    v_mov_b64 v[46:47], 0
    v_mov_b64 v[48:49], 0
    v_mov_b64 v[50:51], 0
    v_mov_b64 v[52:53], 0
    v_mov_b64 v[54:55], 0
    v_mov_b64 v[56:57], 0
    v_mov_b64 v[58:59], 0
    v_mov_b64 v[60:61], 0
    v_mov_b64 v[62:63], 0
    v_mov_b64 v[64:65], 0
    v_mov_b64 v[66:67], 0
    v_mov_b64 v[68:69], 0
    v_mov_b64 v[70:71], 0
    v_mov_b64 v[72:73], 0
    v_mov_b64 v[74:75], 0
    v_mov_b64 v[76:77], 0
    v_mov_b64 v[78:79], 0
    v_mov_b64 v[80:81], 0
    v_mov_b64 v[82:83], 0
    v_mov_b64 v[84:85], 0
    v_mov_b64 v[86:87], 0
    v_mov_b64 v[88:89], 0
    v_mov_b64 v[90:91], 0
    v_mov_b64 v[92:93], 0
    v_mov_b64 v[94:95], 0
    v_mov_b64 v[96:97], 0
    v_mov_b64 v[98:99], 0
    v_mov_b64 v[100:101], 0
    v_mov_b64 v[102:103], 0
    v_mov_b64 v[104:105], 0
    v_mov_b64 v[106:107], 0
    v_mov_b64 v[108:109], 0
    v_mov_b64 v[110:111], 0
    v_mov_b64 v[112:113], 0
    s_cmp_eq_u32 s44, 3
    s_cbranch_scc1 L_noscatter
    s_waitcnt vmcnt(5)
    ds_write_b16 v131, v132
    s_waitcnt vmcnt(4)
    ds_write_b16 v131, v133 offset:8
    s_waitcnt vmcnt(3)
    ds_write_b16 v131, v134 offset:256
    s_mov_b32 exec_hi, 0
    s_waitcnt vmcnt(2)
    ds_write_b16 v131, v135 offset:4096
    s_waitcnt vmcnt(1)
    ds_write_b16 v131, v136 offset:4104
    s_waitcnt vmcnt(0)
    ds_write_b16 v131, v137 offset:4352
    s_mov_b64 exec, -1
L_noscatter:
    s_waitcnt lgkmcnt(0)
    s_barrier
    ds_read_b128 a[0:3], v16 offset:0
    ds_read_b128 a[24:27], v16 offset:6144
    ds_read_b128 a[48:51], v16 offset:12288
    ds_read_b128 v[114:117], v154 offset:0
    ds_read_b128 v[118:121], v155 offset:0
    ds_read_b128 v[122:125], v154 offset:3072
    ds_read_b128 v[126:129], v155 offset:3072
    ds_read_b128 v[130:133], v154 offset:6144
    ds_read_b128 v[134:137], v155 offset:6144
    ds_read_b128 v[138:141], v154 offset:9216
    ds_read_b128 v[142:145], v155 offset:9216
    ds_read_b128 v[146:149], v154 offset:12288
    ds_read_b128 v[150:153], v155 offset:12288
    ds_read_b128 a[72:75], v154 offset:15360
    ds_read_b128 a[76:79], v155 offset:15360
    s_waitcnt lgkmcnt(10)
    v_smfmac_f32_16x16x64_bf16 v[18:21], a[0:3], v[114:121], v158
    ds_read_b128 a[4:7], v16 offset:1024
    ds_read_b128 a[28:31], v16 offset:7168
    ds_read_b128 a[52:55], v16 offset:13312
    ds_read_b128 a[80:83], v156 offset:0
    ds_read_b128 a[84:87], v157 offset:0
    s_waitcnt lgkmcnt(13)
    v_smfmac_f32_16x16x64_bf16 v[18:21], a[24:27], v[122:129], v158
    ds_read_b128 a[88:91], v156 offset:3072
    ds_read_b128 a[92:95], v157 offset:3072
    v_smfmac_f32_16x16x64_bf16 v[42:45], a[0:3], v[122:129], v158
    s_waitcnt lgkmcnt(13)
    v_smfmac_f32_16x16x64_bf16 v[18:21], a[48:51], v[130:137], v158
    ds_read_b128 v[114:117], v156 offset:6144
    ds_read_b128 v[118:121], v157 offset:6144
    v_smfmac_f32_16x16x64_bf16 v[42:45], a[24:27], v[130:137], v158
    v_smfmac_f32_16x16x64_bf16 v[66:69], a[0:3], v[130:137], v158
    s_waitcnt lgkmcnt(13)
    v_smfmac_f32_16x16x64_bf16 v[42:45], a[48:51], v[138:145], v158
    ds_read_b128 v[122:125], v156 offset:9216
    ds_read_b128 v[126:129], v157 offset:9216
    v_smfmac_f32_16x16x64_bf16 v[66:69], a[24:27], v[138:145], v158
    v_smfmac_f32_16x16x64_bf16 v[90:93], a[0:3], v[138:145], v158
    s_waitcnt lgkmcnt(13)
    v_smfmac_f32_16x16x64_bf16 v[66:69], a[48:51], v[146:153], v158
    ds_read_b128 v[130:133], v156 offset:12288
    ds_read_b128 v[134:137], v157 offset:12288
    v_smfmac_f32_16x16x64_bf16 v[90:93], a[24:27], v[146:153], v158
    s_waitcnt lgkmcnt(13)
    v_smfmac_f32_16x16x64_bf16 v[90:93], a[48:51], a[72:79], v158
    ds_read_b128 v[138:141], v156 offset:15360
    ds_read_b128 v[142:145], v157 offset:15360
    s_waitcnt lgkmcnt(10)
    v_smfmac_f32_16x16x64_bf16 v[22:25], a[4:7], a[80:87], v158
    ds_read_b128 a[8:11], v16 offset:2048
    ds_read_b128 a[32:35], v16 offset:8192
    ds_read_b128 a[56:59], v16 offset:14336
    ds_read_b128 v[146:149], v154 offset:1024
    ds_read_b128 v[150:153], v155 offset:1024
    s_waitcnt lgkmcnt(13)
    v_smfmac_f32_16x16x64_bf16 v[22:25], a[28:31], a[88:95], v158
    ds_read_b128 a[72:75], v154 offset:4096
    ds_read_b128 a[76:79], v155 offset:4096
    v_smfmac_f32_16x16x64_bf16 v[46:49], a[4:7], a[88:95], v158
    s_waitcnt lgkmcnt(13)
    v_smfmac_f32_16x16x64_bf16 v[22:25], a[52:55], v[114:121], v158
    ds_read_b128 a[80:83], v154 offset:7168
    ds_read_b128 a[84:87], v155 offset:7168
    v_smfmac_f32_16x16x64_bf16 v[46:49], a[28:31], v[114:121], v158
    v_smfmac_f32_16x16x64_bf16 v[70:73], a[4:7], v[114:121], v158
    s_waitcnt lgkmcnt(13)
    v_smfmac_f32_16x16x64_bf16 v[46:49], a[52:55], v[122:129], v158
    ds_read_b128 a[88:91], v154 offset:10240
    ds_read_b128 a[92:95], v155 offset:10240
    v_smfmac_f32_16x16x64_bf16 v[70:73], a[28:31], v[122:129], v158
    v_smfmac_f32_16x16x64_bf16 v[94:97], a[4:7], v[122:129], v158
    s_waitcnt lgkmcnt(13)
    v_smfmac_f32_16x16x64_bf16 v[70:73], a[52:55], v[130:137], v158
    ds_read_b128 v[114:117], v154 offset:13312
    ds_read_b128 v[118:121], v155 offset:13312
    v_smfmac_f32_16x16x64_bf16 v[94:97], a[28:31], v[130:137], v158
    s_waitcnt lgkmcnt(13)
    v_smfmac_f32_16x16x64_bf16 v[94:97], a[52:55], v[138:145], v158
    ds_read_b128 v[122:125], v154 offset:16384
    ds_read_b128 v[126:129], v155 offset:16384
    s_waitcnt lgkmcnt(10)
    v_smfmac_f32_16x16x64_bf16 v[26:29], a[8:11], v[146:153], v158
    ds_read_b128 a[12:15], v16 offset:3072
    ds_read_b128 a[36:39], v16 offset:9216
    ds_read_b128 a[60:63], v16 offset:15360
    ds_read_b128 v[130:133], v156 offset:1024
    ds_read_b128 v[134:137], v157 offset:1024
    s_waitcnt lgkmcnt(13)
    v_smfmac_f32_16x16x64_bf16 v[26:29], a[32:35], a[72:79], v158
    ds_read_b128 v[138:141], v156 offset:4096
    ds_read_b128 v[142:145], v157 offset:4096
    v_smfmac_f32_16x16x64_bf16 v[50:53], a[8:11], a[72:79], v158
    s_waitcnt lgkmcnt(13)
    v_smfmac_f32_16x16x64_bf16 v[26:29], a[56:59], a[80:87], v158
    ds_read_b128 v[146:149], v156 offset:7168
    ds_read_b128 v[150:153], v157 offset:7168
    v_smfmac_f32_16x16x64_bf16 v[50:53], a[32:35], a[80:87], v158
    v_smfmac_f32_16x16x64_bf16 v[74:77], a[8:11], a[80:87], v158
    s_waitcnt lgkmcnt(13)
    v_smfmac_f32_16x16x64_bf16 v[50:53], a[56:59], a[88:95], v158
    ds_read_b128 a[72:75], v156 offset:10240
    ds_read_b128 a[76:79], v157 offset:10240
    v_smfmac_f32_16x16x64_bf16 v[74:77], a[32:35], a[88:95], v158
    v_smfmac_f32_16x16x64_bf16 v[98:101], a[8:11], a[88:95], v158
    s_waitcnt lgkmcnt(13)
    v_smfmac_f32_16x16x64_bf16 v[74:77], a[56:59], v[114:121], v158
    ds_read_b128 a[80:83], v156 offset:13312
    ds_read_b128 a[84:87], v157 offset:13312
    v_smfmac_f32_16x16x64_bf16 v[98:101], a[32:35], v[114:121], v158
    s_waitcnt lgkmcnt(13)
    v_smfmac_f32_16x16x64_bf16 v[98:101], a[56:59], v[122:129], v158
    ds_read_b128 a[88:91], v156 offset:16384
    ds_read_b128 a[92:95], v157 offset:16384
    s_waitcnt lgkmcnt(10)
    v_smfmac_f32_16x16x64_bf16 v[30:33], a[12:15], v[130:137], v158
    ds_read_b128 a[16:19], v16 offset:4096
    ds_read_b128 a[40:43], v16 offset:10240
    ds_read_b128 a[64:67], v16 offset:16384
    ds_read_b128 v[114:117], v154 offset:2048
    ds_read_b128 v[118:121], v155 offset:2048
    s_waitcnt lgkmcnt(13)
    v_smfmac_f32_16x16x64_bf16 v[30:33], a[36:39], v[138:145], v158
    ds_read_b128 v[122:125], v154 offset:5120
    ds_read_b128 v[126:129], v155 offset:5120
    v_smfmac_f32_16x16x64_bf16 v[54:57], a[12:15], v[138:145], v158
    s_waitcnt lgkmcnt(13)
    v_smfmac_f32_16x16x64_bf16 v[30:33], a[60:63], v[146:153], v158
    ds_read_b128 v[130:133], v154 offset:8192
    ds_read_b128 v[134:137], v155 offset:8192
    v_smfmac_f32_16x16x64_bf16 v[54:57], a[36:39], v[146:153], v158
    v_smfmac_f32_16x16x64_bf16 v[78:81], a[12:15], v[146:153], v158
    s_waitcnt lgkmcnt(13)
    v_smfmac_f32_16x16x64_bf16 v[54:57], a[60:63], a[72:79], v158
    ds_read_b128 v[138:141], v154 offset:11264
    ds_read_b128 v[142:145], v155 offset:11264
    v_smfmac_f32_16x16x64_bf16 v[78:81], a[36:39], a[72:79], v158
    v_smfmac_f32_16x16x64_bf16 v[102:105], a[12:15], a[72:79], v158
    s_waitcnt lgkmcnt(13)
    v_smfmac_f32_16x16x64_bf16 v[78:81], a[60:63], a[80:87], v158
    ds_read_b128 v[146:149], v154 offset:14336
    ds_read_b128 v[150:153], v155 offset:14336
    v_smfmac_f32_16x16x64_bf16 v[102:105], a[36:39], a[80:87], v158
    s_waitcnt lgkmcnt(13)
    v_smfmac_f32_16x16x64_bf16 v[102:105], a[60:63], a[88:95], v158
    ds_read_b128 a[72:75], v154 offset:17408
    ds_read_b128 a[76:79], v155 offset:17408
    s_waitcnt lgkmcnt(10)
    v_smfmac_f32_16x16x64_bf16 v[34:37], a[16:19], v[114:121], v158
    ds_read_b128 a[20:23], v16 offset:5120
    ds_read_b128 a[44:47], v16 offset:11264
    ds_read_b128 a[68:71], v16 offset:17408
    ds_read_b128 a[80:83], v156 offset:2048
    ds_read_b128 a[84:87], v157 offset:2048
    s_waitcnt lgkmcnt(13)
    v_smfmac_f32_16x16x64_bf16 v[34:37], a[40:43], v[122:129], v158
    ds_read_b128 a[88:91], v156 offset:5120
    ds_read_b128 a[92:95], v157 offset:5120
    v_smfmac_f32_16x16x64_bf16 v[58:61], a[16:19], v[122:129], v158
    s_waitcnt lgkmcnt(13)
    v_smfmac_f32_16x16x64_bf16 v[34:37], a[64:67], v[130:137], v158
    ds_read_b128 v[114:117], v156 offset:8192
    ds_read_b128 v[118:121], v157 offset:8192
    v_smfmac_f32_16x16x64_bf16 v[58:61], a[40:43], v[130:137], v158
    v_smfmac_f32_16x16x64_bf16 v[82:85], a[16:19], v[130:137], v158
    s_waitcnt lgkmcnt(13)
    v_smfmac_f32_16x16x64_bf16 v[58:61], a[64:67], v[138:145], v158
    ds_read_b128 v[122:125], v156 offset:11264
    ds_read_b128 v[126:129], v157 offset:11264
    v_smfmac_f32_16x16x64_bf16 v[82:85], a[40:43], v[138:145], v158
    v_smfmac_f32_16x16x64_bf16 v[106:109], a[16:19], v[138:145], v158
    s_waitcnt lgkmcnt(13)
    v_smfmac_f32_16x16x64_bf16 v[82:85], a[64:67], v[146:153], v158
    ds_read_b128 v[130:133], v156 offset:14336
    ds_read_b128 v[134:137], v157 offset:14336
    v_smfmac_f32_16x16x64_bf16 v[106:109], a[40:43], v[146:153], v158
    s_waitcnt lgkmcnt(13)
    v_smfmac_f32_16x16x64_bf16 v[106:109], a[64:67], a[72:79], v158
    ds_read_b128 v[138:141], v156 offset:17408
    ds_read_b128 v[142:145], v157 offset:17408
    s_waitcnt lgkmcnt(10)
    v_smfmac_f32_16x16x64_bf16 v[38:41], a[20:23], a[80:87], v158
    s_waitcnt lgkmcnt(8)
    v_smfmac_f32_16x16x64_bf16 v[38:41], a[44:47], a[88:95], v158
    v_smfmac_f32_16x16x64_bf16 v[62:65], a[20:23], a[88:95], v158
    s_waitcnt lgkmcnt(6)
    v_smfmac_f32_16x16x64_bf16 v[38:41], a[68:71], v[114:121], v158
    v_smfmac_f32_16x16x64_bf16 v[62:65], a[44:47], v[114:121], v158
    v_smfmac_f32_16x16x64_bf16 v[86:89], a[20:23], v[114:121], v158
    s_waitcnt lgkmcnt(4)
    v_smfmac_f32_16x16x64_bf16 v[62:65], a[68:71], v[122:129], v158
    v_smfmac_f32_16x16x64_bf16 v[86:89], a[44:47], v[122:129], v158
    v_smfmac_f32_16x16x64_bf16 v[110:113], a[20:23], v[122:129], v158
    s_waitcnt lgkmcnt(2)
    v_smfmac_f32_16x16x64_bf16 v[86:89], a[68:71], v[130:137], v158
    v_smfmac_f32_16x16x64_bf16 v[110:113], a[44:47], v[130:137], v158
    s_waitcnt lgkmcnt(0)
    v_smfmac_f32_16x16x64_bf16 v[110:113], a[68:71], v[138:145], v158
L_conv_done:
    s_mov_b32 s48, 1009429163
    v_mov_b32 v15, 925353388
    s_mov_b32 s50, 0xc000c000
    s_mov_b32 s51, 0xc000c000
    v_mov_b32 v13, 1055913304
    v_cndmask_b32 v13, v13, 0, s[50:51]
    v_pk_mul_f32 v[146:147], v[18:19], v[18:19]
    v_pk_mul_f32 v[148:149], v[42:43], v[42:43]
    v_pk_fma_f32 v[146:147], v[20:21], v[20:21], v[146:147]
    v_pk_fma_f32 v[148:149], v[44:45], v[44:45], v[148:149]
    v_pk_add_f32 v[138:139], v[18:19], v[20:21]
    v_pk_add_f32 v[140:141], v[42:43], v[44:45]
    v_pk_fma_f32 v[146:147], v[22:23], v[22:23], v[146:147]
    v_pk_fma_f32 v[148:149], v[46:47], v[46:47], v[148:149]
    v_pk_add_f32 v[138:139], v[138:139], v[22:23]
    v_pk_add_f32 v[140:141], v[140:141], v[46:47]
    v_pk_fma_f32 v[146:147], v[24:25], v[24:25], v[146:147]
    v_pk_fma_f32 v[148:149], v[48:49], v[48:49], v[148:149]
    v_pk_add_f32 v[138:139], v[138:139], v[24:25]
    v_pk_add_f32 v[140:141], v[140:141], v[48:49]
    v_pk_fma_f32 v[146:147], v[26:27], v[26:27], v[146:147]
    v_pk_fma_f32 v[148:149], v[50:51], v[50:51], v[148:149]
    v_pk_add_f32 v[138:139], v[138:139], v[26:27]
    v_pk_add_f32 v[140:141], v[140:141], v[50:51]
    v_pk_fma_f32 v[146:147], v[28:29], v[28:29], v[146:147]
    v_pk_fma_f32 v[148:149], v[52:53], v[52:53], v[148:149]
    v_pk_add_f32 v[138:139], v[138:139], v[28:29]
    v_pk_add_f32 v[140:141], v[140:141], v[52:53]
    v_pk_fma_f32 v[146:147], v[30:31], v[30:31], v[146:147]
    v_pk_fma_f32 v[148:149], v[54:55], v[54:55], v[148:149]
    v_pk_add_f32 v[138:139], v[138:139], v[30:31]
    v_pk_add_f32 v[140:141], v[140:141], v[54:55]
    v_pk_fma_f32 v[146:147], v[32:33], v[32:33], v[146:147]
    v_pk_fma_f32 v[148:149], v[56:57], v[56:57], v[148:149]
    v_pk_add_f32 v[138:139], v[138:139], v[32:33]
    v_pk_add_f32 v[140:141], v[140:141], v[56:57]
    v_pk_fma_f32 v[146:147], v[34:35], v[34:35], v[146:147]
    v_pk_fma_f32 v[148:149], v[58:59], v[58:59], v[148:149]
    v_pk_add_f32 v[138:139], v[138:139], v[34:35]
    v_pk_add_f32 v[140:141], v[140:141], v[58:59]
    v_pk_fma_f32 v[146:147], v[36:37], v[36:37], v[146:147]
    v_pk_fma_f32 v[148:149], v[60:61], v[60:61], v[148:149]
    v_pk_add_f32 v[138:139], v[138:139], v[36:37]
    v_pk_add_f32 v[140:141], v[140:141], v[60:61]
    v_pk_fma_f32 v[146:147], v[38:39], v[38:39], v[146:147]
    v_pk_fma_f32 v[148:149], v[62:63], v[62:63], v[148:149]
    v_pk_add_f32 v[138:139], v[138:139], v[38:39]
    v_pk_add_f32 v[140:141], v[140:141], v[62:63]
    v_pk_fma_f32 v[146:147], v[40:41], v[40:41], v[146:147]
    v_pk_fma_f32 v[148:149], v[64:65], v[64:65], v[148:149]
    v_pk_add_f32 v[138:139], v[138:139], v[40:41]
    v_pk_add_f32 v[140:141], v[140:141], v[64:65]
    v_add_f32 v146, v146, v147
    v_pk_mul_f32 v[150:151], v[66:67], v[66:67]
    v_pk_mul_f32 v[152:153], v[90:91], v[90:91]
    v_add_f32 v148, v148, v149
    v_pk_fma_f32 v[150:151], v[68:69], v[68:69], v[150:151]
    v_pk_fma_f32 v[152:153], v[92:93], v[92:93], v[152:153]
    v_add_f32 v138, v138, v139
    v_pk_add_f32 v[142:143], v[66:67], v[68:69]
    v_pk_add_f32 v[144:145], v[90:91], v[92:93]
    v_add_f32 v140, v140, v141
    v_pk_fma_f32 v[150:151], v[70:71], v[70:71], v[150:151]
    v_pk_fma_f32 v[152:153], v[94:95], v[94:95], v[152:153]
    v_permlane32_swap_b32 v138, v146
    v_pk_add_f32 v[142:143], v[142:143], v[70:71]
    v_pk_add_f32 v[144:145], v[144:145], v[94:95]
    v_permlane32_swap_b32 v140, v148
    v_pk_fma_f32 v[150:151], v[72:73], v[72:73], v[150:151]
    v_pk_fma_f32 v[152:153], v[96:97], v[96:97], v[152:153]
    v_add_f32 v138, v138, v146
    v_pk_add_f32 v[142:143], v[142:143], v[72:73]
    v_pk_add_f32 v[144:145], v[144:145], v[96:97]
    v_add_f32 v140, v140, v148
    v_pk_fma_f32 v[150:151], v[74:75], v[74:75], v[150:151]
    v_pk_fma_f32 v[152:153], v[98:99], v[98:99], v[152:153]
    v_permlane16_swap_b32 v138, v140
    v_pk_add_f32 v[142:143], v[142:143], v[74:75]
    v_pk_add_f32 v[144:145], v[144:145], v[98:99]
    v_add_f32 v138, v138, v140
    v_pk_fma_f32 v[150:151], v[76:77], v[76:77], v[150:151]
    v_pk_fma_f32 v[152:153], v[100:101], v[100:101], v[152:153]
    v_mov_b32 v139, v138
    v_pk_add_f32 v[142:143], v[142:143], v[76:77]
    v_pk_add_f32 v[144:145], v[144:145], v[100:101]
    v_permlane32_swap_b32 v139, v138
    v_pk_fma_f32 v[150:151], v[78:79], v[78:79], v[150:151]
    v_pk_fma_f32 v[152:153], v[102:103], v[102:103], v[152:153]
    v_mul_f32 v139, s48, v139
    v_pk_add_f32 v[142:143], v[142:143], v[78:79]
    v_pk_add_f32 v[144:145], v[144:145], v[102:103]
    v_fma_f32 v138, v138, s48, v15
    v_pk_fma_f32 v[150:151], v[80:81], v[80:81], v[150:151]
    v_pk_fma_f32 v[152:153], v[104:105], v[104:105], v[152:153]
    v_fma_f32 v138, -v139, v139, v138
    v_pk_add_f32 v[142:143], v[142:143], v[80:81]
    v_pk_add_f32 v[144:145], v[144:145], v[104:105]
    v_max_f32 v138, v138, v15
    v_pk_fma_f32 v[150:151], v[82:83], v[82:83], v[150:151]
    v_pk_fma_f32 v[152:153], v[106:107], v[106:107], v[152:153]
    v_rsq_f32 v138, v138
    v_pk_add_f32 v[142:143], v[142:143], v[82:83]
    v_pk_add_f32 v[144:145], v[144:145], v[106:107]
    v_mul_f32 v115, v13, v138
    v_pk_fma_f32 v[150:151], v[84:85], v[84:85], v[150:151]
    v_pk_fma_f32 v[152:153], v[108:109], v[108:109], v[152:153]
    v_mul_f32 v117, v139, v115
    v_pk_add_f32 v[142:143], v[142:143], v[84:85]
    v_pk_add_f32 v[144:145], v[144:145], v[108:109]
    v_mov_b32 v114, v115
    v_pk_fma_f32 v[150:151], v[86:87], v[86:87], v[150:151]
    v_pk_fma_f32 v[152:153], v[110:111], v[110:111], v[152:153]
    v_mov_b32 v116, v117
    v_pk_add_f32 v[142:143], v[142:143], v[86:87]
    v_pk_add_f32 v[144:145], v[144:145], v[110:111]
    v_permlane16_swap_b32 v114, v115
    v_pk_fma_f32 v[150:151], v[88:89], v[88:89], v[150:151]
    v_pk_fma_f32 v[152:153], v[112:113], v[112:113], v[152:153]
    v_permlane16_swap_b32 v116, v117
    v_pk_add_f32 v[142:143], v[142:143], v[88:89]
    v_pk_add_f32 v[144:145], v[144:145], v[112:113]
    v_pk_fma_f32 v[18:19], v[18:19], v[114:115], v[116:117] op_sel:[0,0,0] op_sel_hi:[1,0,0] neg_lo:[0,0,1] neg_hi:[0,0,1]
    v_add_f32 v150, v150, v151
    v_pk_fma_f32 v[20:21], v[20:21], v[114:115], v[116:117] op_sel:[0,0,0] op_sel_hi:[1,0,0] neg_lo:[0,0,1] neg_hi:[0,0,1]
    v_pk_fma_f32 v[22:23], v[22:23], v[114:115], v[116:117] op_sel:[0,0,0] op_sel_hi:[1,0,0] neg_lo:[0,0,1] neg_hi:[0,0,1]
    v_add_f32 v152, v152, v153
    v_pk_fma_f32 v[24:25], v[24:25], v[114:115], v[116:117] op_sel:[0,0,0] op_sel_hi:[1,0,0] neg_lo:[0,0,1] neg_hi:[0,0,1]
    v_cvt_pk_bf16_f32 v122, v18, v19
    v_add_f32 v142, v142, v143
    v_cvt_pk_bf16_f32 v123, v20, v21
    v_cvt_pk_bf16_f32 v124, v22, v23
    v_cvt_pk_bf16_f32 v125, v24, v25
    v_add_f32 v144, v144, v145
    v_pk_fma_f32 v[26:27], v[26:27], v[114:115], v[116:117] op_sel:[0,0,0] op_sel_hi:[1,0,0] neg_lo:[0,0,1] neg_hi:[0,0,1]
    v_pk_fma_f32 v[28:29], v[28:29], v[114:115], v[116:117] op_sel:[0,0,0] op_sel_hi:[1,0,0] neg_lo:[0,0,1] neg_hi:[0,0,1]
    v_permlane32_swap_b32 v142, v150
    v_pk_fma_f32 v[30:31], v[30:31], v[114:115], v[116:117] op_sel:[0,0,0] op_sel_hi:[1,0,0] neg_lo:[0,0,1] neg_hi:[0,0,1]
    v_pk_fma_f32 v[32:33], v[32:33], v[114:115], v[116:117] op_sel:[0,0,0] op_sel_hi:[1,0,0] neg_lo:[0,0,1] neg_hi:[0,0,1]
    v_permlane32_swap_b32 v144, v152
    ds_write_b128 v159, v[122:125] offset:0
    v_cvt_pk_bf16_f32 v126, v26, v27
    v_cvt_pk_bf16_f32 v127, v28, v29
    v_add_f32 v142, v142, v150
    v_cvt_pk_bf16_f32 v128, v30, v31
    v_cvt_pk_bf16_f32 v129, v32, v33
    v_add_f32 v144, v144, v152
    v_pk_fma_f32 v[34:35], v[34:35], v[114:115], v[116:117] op_sel:[0,0,0] op_sel_hi:[1,0,0] neg_lo:[0,0,1] neg_hi:[0,0,1]
    v_pk_fma_f32 v[36:37], v[36:37], v[114:115], v[116:117] op_sel:[0,0,0] op_sel_hi:[1,0,0] neg_lo:[0,0,1] neg_hi:[0,0,1]
    v_pk_fma_f32 v[38:39], v[38:39], v[114:115], v[116:117] op_sel:[0,0,0] op_sel_hi:[1,0,0] neg_lo:[0,0,1] neg_hi:[0,0,1]
    v_permlane16_swap_b32 v142, v144
    v_pk_fma_f32 v[40:41], v[40:41], v[114:115], v[116:117] op_sel:[0,0,0] op_sel_hi:[1,0,0] neg_lo:[0,0,1] neg_hi:[0,0,1]
    ds_write_b128 v159, v[126:129] offset:2048
    v_add_f32 v142, v142, v144
    v_cvt_pk_bf16_f32 v130, v34, v35
    v_cvt_pk_bf16_f32 v131, v36, v37
    v_mov_b32 v143, v142
    v_cvt_pk_bf16_f32 v132, v38, v39
    v_cvt_pk_bf16_f32 v133, v40, v41
    v_xor_b32 v17, 64, v159
    v_permlane32_swap_b32 v143, v142
    v_pk_fma_f32 v[42:43], v[42:43], v[114:115], v[116:117] op_sel:[0,1,1] op_sel_hi:[1,1,1] neg_lo:[0,0,1] neg_hi:[0,0,1]
    v_pk_fma_f32 v[44:45], v[44:45], v[114:115], v[116:117] op_sel:[0,1,1] op_sel_hi:[1,1,1] neg_lo:[0,0,1] neg_hi:[0,0,1]
    v_mul_f32 v143, s48, v143
    v_pk_fma_f32 v[46:47], v[46:47], v[114:115], v[116:117] op_sel:[0,1,1] op_sel_hi:[1,1,1] neg_lo:[0,0,1] neg_hi:[0,0,1]
    v_pk_fma_f32 v[48:49], v[48:49], v[114:115], v[116:117] op_sel:[0,1,1] op_sel_hi:[1,1,1] neg_lo:[0,0,1] neg_hi:[0,0,1]
    ds_write_b128 v159, v[130:133] offset:4096
    v_fma_f32 v142, v142, s48, v15
    v_cvt_pk_bf16_f32 v134, v42, v43
    v_cvt_pk_bf16_f32 v135, v44, v45
    v_fma_f32 v142, -v143, v143, v142
    v_cvt_pk_bf16_f32 v136, v46, v47
    v_cvt_pk_bf16_f32 v137, v48, v49
    v_max_f32 v142, v142, v15
    v_pk_fma_f32 v[50:51], v[50:51], v[114:115], v[116:117] op_sel:[0,1,1] op_sel_hi:[1,1,1] neg_lo:[0,0,1] neg_hi:[0,0,1]
    v_pk_fma_f32 v[52:53], v[52:53], v[114:115], v[116:117] op_sel:[0,1,1] op_sel_hi:[1,1,1] neg_lo:[0,0,1] neg_hi:[0,0,1]
    v_pk_fma_f32 v[54:55], v[54:55], v[114:115], v[116:117] op_sel:[0,1,1] op_sel_hi:[1,1,1] neg_lo:[0,0,1] neg_hi:[0,0,1]
    v_rsq_f32 v142, v142
    v_pk_fma_f32 v[56:57], v[56:57], v[114:115], v[116:117] op_sel:[0,1,1] op_sel_hi:[1,1,1] neg_lo:[0,0,1] neg_hi:[0,0,1]
    ds_write_b128 v17, v[134:137] offset:0
    v_mul_f32 v119, v13, v142
    v_cvt_pk_bf16_f32 v122, v50, v51
    v_cvt_pk_bf16_f32 v123, v52, v53
    v_cvt_pk_bf16_f32 v124, v54, v55
    v_mul_f32 v121, v143, v119
    v_cvt_pk_bf16_f32 v125, v56, v57
    v_pk_fma_f32 v[58:59], v[58:59], v[114:115], v[116:117] op_sel:[0,1,1] op_sel_hi:[1,1,1] neg_lo:[0,0,1] neg_hi:[0,0,1]
    v_mov_b32 v118, v119
    v_pk_fma_f32 v[60:61], v[60:61], v[114:115], v[116:117] op_sel:[0,1,1] op_sel_hi:[1,1,1] neg_lo:[0,0,1] neg_hi:[0,0,1]
    v_pk_fma_f32 v[62:63], v[62:63], v[114:115], v[116:117] op_sel:[0,1,1] op_sel_hi:[1,1,1] neg_lo:[0,0,1] neg_hi:[0,0,1]
    v_mov_b32 v120, v121
    v_pk_fma_f32 v[64:65], v[64:65], v[114:115], v[116:117] op_sel:[0,1,1] op_sel_hi:[1,1,1] neg_lo:[0,0,1] neg_hi:[0,0,1]
    ds_write_b128 v17, v[122:125] offset:2048
    v_cvt_pk_bf16_f32 v126, v58, v59
    v_permlane16_swap_b32 v118, v119
    v_cvt_pk_bf16_f32 v127, v60, v61
    v_cvt_pk_bf16_f32 v128, v62, v63
    v_permlane16_swap_b32 v120, v121
    v_cvt_pk_bf16_f32 v129, v64, v65
    ds_write_b128 v17, v[126:129] offset:4096
    s_waitcnt lgkmcnt(0)
    s_barrier
    s_setprio 3
    ds_read_b64_tr_b16 a[0:1], v12 offset:0
    ds_read_b64_tr_b16 a[2:3], v12 offset:1024
    ds_read_b64_tr_b16 a[4:5], v12 offset:512
    ds_read_b64_tr_b16 a[6:7], v12 offset:1536
    ds_read_b64_tr_b16 a[8:9], v12 offset:2048
    ds_read_b64_tr_b16 a[10:11], v12 offset:3072
    ds_read_b64_tr_b16 a[12:13], v12 offset:2560
    ds_read_b64_tr_b16 a[14:15], v12 offset:3584
    ds_read_b64_tr_b16 a[16:17], v12 offset:4096
    ds_read_b64_tr_b16 a[18:19], v12 offset:5120
    ds_read_b64_tr_b16 a[20:21], v12 offset:4608
    ds_read_b64_tr_b16 a[22:23], v12 offset:5632
    s_cmp_eq_u32 s44, 3
    s_cbranch_scc1 L_ln_done
    v_pk_fma_f32 v[66:67], v[66:67], v[118:119], v[120:121] op_sel:[0,0,0] op_sel_hi:[1,0,0] neg_lo:[0,0,1] neg_hi:[0,0,1]
    v_pk_fma_f32 v[68:69], v[68:69], v[118:119], v[120:121] op_sel:[0,0,0] op_sel_hi:[1,0,0] neg_lo:[0,0,1] neg_hi:[0,0,1]
    v_pk_fma_f32 v[70:71], v[70:71], v[118:119], v[120:121] op_sel:[0,0,0] op_sel_hi:[1,0,0] neg_lo:[0,0,1] neg_hi:[0,0,1]
    v_pk_fma_f32 v[72:73], v[72:73], v[118:119], v[120:121] op_sel:[0,0,0] op_sel_hi:[1,0,0] neg_lo:[0,0,1] neg_hi:[0,0,1]
    v_cvt_pk_bf16_f32 v122, v66, v67
    v_cvt_pk_bf16_f32 v123, v68, v69
    v_cvt_pk_bf16_f32 v124, v70, v71
    v_cvt_pk_bf16_f32 v125, v72, v73
    v_pk_fma_f32 v[74:75], v[74:75], v[118:119], v[120:121] op_sel:[0,0,0] op_sel_hi:[1,0,0] neg_lo:[0,0,1] neg_hi:[0,0,1]
    v_pk_fma_f32 v[76:77], v[76:77], v[118:119], v[120:121] op_sel:[0,0,0] op_sel_hi:[1,0,0] neg_lo:[0,0,1] neg_hi:[0,0,1]
    v_pk_fma_f32 v[78:79], v[78:79], v[118:119], v[120:121] op_sel:[0,0,0] op_sel_hi:[1,0,0] neg_lo:[0,0,1] neg_hi:[0,0,1]
    v_pk_fma_f32 v[80:81], v[80:81], v[118:119], v[120:121] op_sel:[0,0,0] op_sel_hi:[1,0,0] neg_lo:[0,0,1] neg_hi:[0,0,1]
    ds_write_b128 v9, v[122:125] offset:0
    v_cvt_pk_bf16_f32 v126, v74, v75
    v_cvt_pk_bf16_f32 v127, v76, v77
    v_cvt_pk_bf16_f32 v128, v78, v79
    v_cvt_pk_bf16_f32 v129, v80, v81
    v_pk_fma_f32 v[82:83], v[82:83], v[118:119], v[120:121] op_sel:[0,0,0] op_sel_hi:[1,0,0] neg_lo:[0,0,1] neg_hi:[0,0,1]
    v_pk_fma_f32 v[84:85], v[84:85], v[118:119], v[120:121] op_sel:[0,0,0] op_sel_hi:[1,0,0] neg_lo:[0,0,1] neg_hi:[0,0,1]
    v_pk_fma_f32 v[86:87], v[86:87], v[118:119], v[120:121] op_sel:[0,0,0] op_sel_hi:[1,0,0] neg_lo:[0,0,1] neg_hi:[0,0,1]
    v_pk_fma_f32 v[88:89], v[88:89], v[118:119], v[120:121] op_sel:[0,0,0] op_sel_hi:[1,0,0] neg_lo:[0,0,1] neg_hi:[0,0,1]
    ds_write_b128 v9, v[126:129] offset:2048
    v_cvt_pk_bf16_f32 v130, v82, v83
    v_cvt_pk_bf16_f32 v131, v84, v85
    v_cvt_pk_bf16_f32 v132, v86, v87
    v_cvt_pk_bf16_f32 v133, v88, v89
    v_xor_b32 v17, 64, v9
    v_pk_fma_f32 v[90:91], v[90:91], v[118:119], v[120:121] op_sel:[0,1,1] op_sel_hi:[1,1,1] neg_lo:[0,0,1] neg_hi:[0,0,1]
    v_pk_fma_f32 v[92:93], v[92:93], v[118:119], v[120:121] op_sel:[0,1,1] op_sel_hi:[1,1,1] neg_lo:[0,0,1] neg_hi:[0,0,1]
    v_pk_fma_f32 v[94:95], v[94:95], v[118:119], v[120:121] op_sel:[0,1,1] op_sel_hi:[1,1,1] neg_lo:[0,0,1] neg_hi:[0,0,1]
    v_pk_fma_f32 v[96:97], v[96:97], v[118:119], v[120:121] op_sel:[0,1,1] op_sel_hi:[1,1,1] neg_lo:[0,0,1] neg_hi:[0,0,1]
    ds_write_b128 v9, v[130:133] offset:4096
    v_cvt_pk_bf16_f32 v134, v90, v91
    v_cvt_pk_bf16_f32 v135, v92, v93
    v_cvt_pk_bf16_f32 v136, v94, v95
    v_cvt_pk_bf16_f32 v137, v96, v97
    v_pk_fma_f32 v[98:99], v[98:99], v[118:119], v[120:121] op_sel:[0,1,1] op_sel_hi:[1,1,1] neg_lo:[0,0,1] neg_hi:[0,0,1]
    v_pk_fma_f32 v[100:101], v[100:101], v[118:119], v[120:121] op_sel:[0,1,1] op_sel_hi:[1,1,1] neg_lo:[0,0,1] neg_hi:[0,0,1]
    v_pk_fma_f32 v[102:103], v[102:103], v[118:119], v[120:121] op_sel:[0,1,1] op_sel_hi:[1,1,1] neg_lo:[0,0,1] neg_hi:[0,0,1]
    v_pk_fma_f32 v[104:105], v[104:105], v[118:119], v[120:121] op_sel:[0,1,1] op_sel_hi:[1,1,1] neg_lo:[0,0,1] neg_hi:[0,0,1]
    ds_write_b128 v17, v[134:137] offset:0
    v_cvt_pk_bf16_f32 v122, v98, v99
    v_cvt_pk_bf16_f32 v123, v100, v101
    v_cvt_pk_bf16_f32 v124, v102, v103
    v_cvt_pk_bf16_f32 v125, v104, v105
    v_pk_fma_f32 v[106:107], v[106:107], v[118:119], v[120:121] op_sel:[0,1,1] op_sel_hi:[1,1,1] neg_lo:[0,0,1] neg_hi:[0,0,1]
    v_pk_fma_f32 v[108:109], v[108:109], v[118:119], v[120:121] op_sel:[0,1,1] op_sel_hi:[1,1,1] neg_lo:[0,0,1] neg_hi:[0,0,1]
    v_pk_fma_f32 v[110:111], v[110:111], v[118:119], v[120:121] op_sel:[0,1,1] op_sel_hi:[1,1,1] neg_lo:[0,0,1] neg_hi:[0,0,1]
    v_pk_fma_f32 v[112:113], v[112:113], v[118:119], v[120:121] op_sel:[0,1,1] op_sel_hi:[1,1,1] neg_lo:[0,0,1] neg_hi:[0,0,1]
    ds_write_b128 v17, v[122:125] offset:2048
    v_cvt_pk_bf16_f32 v126, v106, v107
    v_cvt_pk_bf16_f32 v127, v108, v109
    v_cvt_pk_bf16_f32 v128, v110, v111
    v_cvt_pk_bf16_f32 v129, v112, v113
    ds_write_b128 v17, v[126:129] offset:4096
L_ln_done:
    ds_read_b128 a[72:75], v4 offset:0
    ds_read_b128 a[76:79], v4 offset:1024
    ds_read_b128 a[80:83], v4 offset:2048
    ds_read_b128 a[84:87], v4 offset:3072
    ds_read_b128 a[88:91], v4 offset:4096
    ds_read_b128 a[92:95], v4 offset:5120
    ds_read_b64_tr_b16 a[24:25], v12 offset:6144
    ds_read_b64_tr_b16 a[26:27], v12 offset:7168
    ds_read_b64_tr_b16 a[28:29], v12 offset:6656
    ds_read_b64_tr_b16 a[30:31], v12 offset:7680
    ds_read_b64_tr_b16 a[32:33], v12 offset:8192
    ds_read_b64_tr_b16 a[34:35], v12 offset:9216
    ds_read_b64_tr_b16 a[36:37], v12 offset:8704
    ds_read_b64_tr_b16 a[38:39], v12 offset:9728
    ds_read_b64_tr_b16 a[40:41], v12 offset:10240
    ds_read_b64_tr_b16 a[42:43], v12 offset:11264
    ds_read_b64_tr_b16 a[44:45], v12 offset:10752
    ds_read_b64_tr_b16 a[46:47], v12 offset:11776
    ds_read_b64_tr_b16 a[48:49], v12 offset:12288
    ds_read_b64_tr_b16 a[50:51], v12 offset:13312
    ds_read_b64_tr_b16 a[52:53], v12 offset:12800
    ds_read_b64_tr_b16 a[54:55], v12 offset:13824
    ds_read_b64_tr_b16 a[56:57], v12 offset:14336
    ds_read_b64_tr_b16 a[58:59], v12 offset:15360
    ds_read_b64_tr_b16 a[60:61], v12 offset:14848
    ds_read_b64_tr_b16 a[62:63], v12 offset:15872
    ds_read_b64_tr_b16 a[64:65], v12 offset:16384
    ds_read_b64_tr_b16 a[66:67], v12 offset:17408
    ds_read_b64_tr_b16 a[68:69], v12 offset:16896
    ds_read_b64_tr_b16 a[70:71], v12 offset:17920
    s_waitcnt lgkmcnt(15)
    v_mfma_f32_32x32x16_bf16 v[18:33], a[72:75], a[0:3], 0
    v_mfma_f32_32x32x16_bf16 v[18:33], a[76:79], a[4:7], v[18:33]
    v_mfma_f32_32x32x16_bf16 v[18:33], a[80:83], a[8:11], v[18:33]
    v_mfma_f32_32x32x16_bf16 v[18:33], a[84:87], a[12:15], v[18:33]
    v_mfma_f32_32x32x16_bf16 v[18:33], a[88:91], a[16:19], v[18:33]
    v_mfma_f32_32x32x16_bf16 v[18:33], a[92:95], a[20:23], v[18:33]
    s_waitcnt lgkmcnt(0)
    s_barrier
    s_setprio 3
    s_nop 8
    v_pk_fma_f32 v[50:51], v[18:19], v[18:19], s[60:61]
    v_pk_fma_f32 v[52:53], v[20:21], v[20:21], s[60:61]
    buffer_load_dwordx4 v[124:127], v0, s[8:11], 0 offen offset:0
    v_pk_fma_f32 v[54:55], v[22:23], v[22:23], s[60:61]
    v_pk_fma_f32 v[56:57], v[24:25], v[24:25], s[60:61]
    v_pk_fma_f32 v[58:59], v[26:27], v[26:27], s[60:61]
    v_pk_fma_f32 v[60:61], v[28:29], v[28:29], s[60:61]
    v_pk_fma_f32 v[62:63], v[30:31], v[30:31], s[60:61]
    v_pk_mul_f32 v[50:51], v[18:19], v[50:51] neg_lo:[1,0] neg_hi:[1,0]
    v_pk_mul_f32 v[52:53], v[20:21], v[52:53] neg_lo:[1,0] neg_hi:[1,0]
    v_pk_mul_f32 v[54:55], v[22:23], v[54:55] neg_lo:[1,0] neg_hi:[1,0]
    v_pk_mul_f32 v[56:57], v[24:25], v[56:57] neg_lo:[1,0] neg_hi:[1,0]
    v_pk_mul_f32 v[58:59], v[26:27], v[58:59] neg_lo:[1,0] neg_hi:[1,0]
    v_pk_mul_f32 v[60:61], v[28:29], v[60:61] neg_lo:[1,0] neg_hi:[1,0]
    v_pk_mul_f32 v[62:63], v[30:31], v[62:63] neg_lo:[1,0] neg_hi:[1,0]
    v_mfma_f32_32x32x16_bf16 v[34:49], a[72:75], a[24:27], 0
    v_exp_f32 v50, v50
    v_exp_f32 v51, v51
    v_exp_f32 v52, v52
    v_mfma_f32_32x32x16_bf16 v[34:49], a[76:79], a[28:31], v[34:49]
    v_exp_f32 v53, v53
    v_exp_f32 v54, v54
    v_exp_f32 v55, v55
    v_mfma_f32_32x32x16_bf16 v[34:49], a[80:83], a[32:35], v[34:49]
    v_exp_f32 v56, v56
    v_exp_f32 v57, v57
    v_exp_f32 v58, v58
    v_exp_f32 v59, v59
    v_exp_f32 v60, v60
    v_exp_f32 v61, v61
    v_exp_f32 v62, v62
    v_exp_f32 v63, v63
    v_pk_add_f32 v[50:51], v[50:51], 1.0 op_sel_hi:[1,0]
    v_pk_add_f32 v[52:53], v[52:53], 1.0 op_sel_hi:[1,0]
    v_pk_add_f32 v[54:55], v[54:55], 1.0 op_sel_hi:[1,0]
    v_pk_add_f32 v[56:57], v[56:57], 1.0 op_sel_hi:[1,0]
    v_pk_add_f32 v[58:59], v[58:59], 1.0 op_sel_hi:[1,0]
    v_pk_add_f32 v[60:61], v[60:61], 1.0 op_sel_hi:[1,0]
    v_pk_add_f32 v[62:63], v[62:63], 1.0 op_sel_hi:[1,0]
    v_mfma_f32_32x32x16_bf16 v[34:49], a[84:87], a[36:39], v[34:49]
    v_rcp_f32 v50, v50
    v_rcp_f32 v51, v51
    v_rcp_f32 v52, v52
    v_mfma_f32_32x32x16_bf16 v[34:49], a[88:91], a[40:43], v[34:49]
    v_rcp_f32 v53, v53
    v_rcp_f32 v54, v54
    v_rcp_f32 v55, v55
    v_mfma_f32_32x32x16_bf16 v[34:49], a[92:95], a[44:47], v[34:49]
    v_rcp_f32 v56, v56
    v_rcp_f32 v57, v57
    v_rcp_f32 v58, v58
    v_rcp_f32 v59, v59
    v_rcp_f32 v60, v60
    v_rcp_f32 v61, v61
    v_rcp_f32 v62, v62
    v_rcp_f32 v63, v63
    v_pk_mul_f32 v[50:51], v[18:19], v[50:51]
    v_pk_mul_f32 v[52:53], v[20:21], v[52:53]
    v_pk_mul_f32 v[54:55], v[22:23], v[54:55]
    v_pk_mul_f32 v[56:57], v[24:25], v[56:57]
    v_pk_mul_f32 v[58:59], v[26:27], v[58:59]
    v_pk_mul_f32 v[60:61], v[28:29], v[60:61]
    v_pk_mul_f32 v[62:63], v[30:31], v[62:63]
    v_pk_mul_f32 v[12:13], v[50:51], v[50:51]
    v_cvt_pk_bf16_f32 v64, v50, v51
    v_pk_fma_f32 v[12:13], v[52:53], v[52:53], v[12:13]
    v_cvt_pk_bf16_f32 v65, v52, v53
    v_pk_fma_f32 v[12:13], v[54:55], v[54:55], v[12:13]
    v_cvt_pk_bf16_f32 v66, v54, v55
    v_pk_fma_f32 v[12:13], v[56:57], v[56:57], v[12:13]
    v_cvt_pk_bf16_f32 v67, v56, v57
    ds_write_b128 v5, v[64:67] offset:12288
    v_pk_fma_f32 v[12:13], v[58:59], v[58:59], v[12:13]
    v_cvt_pk_bf16_f32 v88, v58, v59
    v_pk_fma_f32 v[12:13], v[60:61], v[60:61], v[12:13]
    v_cvt_pk_bf16_f32 v89, v60, v61
    v_pk_fma_f32 v[12:13], v[62:63], v[62:63], v[12:13]
    v_cvt_pk_bf16_f32 v90, v62, v63
    v_pk_fma_f32 v[50:51], v[34:35], v[34:35], s[60:61]
    v_pk_fma_f32 v[52:53], v[36:37], v[36:37], s[60:61]
    buffer_load_dwordx4 v[136:139], v1, s[8:11], 0 offen offset:0
    v_pk_fma_f32 v[54:55], v[38:39], v[38:39], s[60:61]
    v_pk_fma_f32 v[56:57], v[40:41], v[40:41], s[60:61]
    v_pk_fma_f32 v[58:59], v[42:43], v[42:43], s[60:61]
    v_pk_fma_f32 v[60:61], v[44:45], v[44:45], s[60:61]
    v_pk_fma_f32 v[62:63], v[46:47], v[46:47], s[60:61]
    v_pk_mul_f32 v[50:51], v[34:35], v[50:51] neg_lo:[1,0] neg_hi:[1,0]
    v_pk_mul_f32 v[52:53], v[36:37], v[52:53] neg_lo:[1,0] neg_hi:[1,0]
    v_pk_mul_f32 v[54:55], v[38:39], v[54:55] neg_lo:[1,0] neg_hi:[1,0]
    v_pk_mul_f32 v[56:57], v[40:41], v[56:57] neg_lo:[1,0] neg_hi:[1,0]
    v_pk_mul_f32 v[58:59], v[42:43], v[58:59] neg_lo:[1,0] neg_hi:[1,0]
    v_pk_mul_f32 v[60:61], v[44:45], v[60:61] neg_lo:[1,0] neg_hi:[1,0]
    v_pk_mul_f32 v[62:63], v[46:47], v[62:63] neg_lo:[1,0] neg_hi:[1,0]
    v_mfma_f32_32x32x16_bf16 v[18:33], a[72:75], a[48:51], 0
    v_exp_f32 v50, v50
    v_exp_f32 v51, v51
    v_exp_f32 v52, v52
    v_mfma_f32_32x32x16_bf16 v[18:33], a[76:79], a[52:55], v[18:33]
    v_exp_f32 v53, v53
    v_exp_f32 v54, v54
    v_exp_f32 v55, v55
    v_mfma_f32_32x32x16_bf16 v[18:33], a[80:83], a[56:59], v[18:33]
    v_exp_f32 v56, v56
    v_exp_f32 v57, v57
    v_exp_f32 v58, v58
    v_exp_f32 v59, v59
    v_exp_f32 v60, v60
    v_exp_f32 v61, v61
    ds_read_b128 a[72:75], v4 offset:18432
    v_exp_f32 v62, v62
    ds_read_b128 a[76:79], v4 offset:19456
    v_exp_f32 v63, v63
    ds_read_b128 a[80:83], v4 offset:20480
    v_pk_add_f32 v[50:51], v[50:51], 1.0 op_sel_hi:[1,0]
    v_pk_add_f32 v[52:53], v[52:53], 1.0 op_sel_hi:[1,0]
    v_pk_add_f32 v[54:55], v[54:55], 1.0 op_sel_hi:[1,0]
    v_pk_add_f32 v[56:57], v[56:57], 1.0 op_sel_hi:[1,0]
    v_pk_add_f32 v[58:59], v[58:59], 1.0 op_sel_hi:[1,0]
    v_pk_add_f32 v[60:61], v[60:61], 1.0 op_sel_hi:[1,0]
    v_pk_add_f32 v[62:63], v[62:63], 1.0 op_sel_hi:[1,0]
    v_mfma_f32_32x32x16_bf16 v[18:33], a[84:87], a[60:63], v[18:33]
    v_rcp_f32 v50, v50
    v_rcp_f32 v51, v51
    v_rcp_f32 v52, v52
    v_mfma_f32_32x32x16_bf16 v[18:33], a[88:91], a[64:67], v[18:33]
    v_rcp_f32 v53, v53
    v_rcp_f32 v54, v54
    v_rcp_f32 v55, v55
    v_mfma_f32_32x32x16_bf16 v[18:33], a[92:95], a[68:71], v[18:33]
    v_rcp_f32 v56, v56
    v_rcp_f32 v57, v57
    v_rcp_f32 v58, v58
    v_rcp_f32 v59, v59
    v_rcp_f32 v60, v60
    v_rcp_f32 v61, v61
    ds_read_b128 a[84:87], v4 offset:21504
    v_rcp_f32 v62, v62
    ds_read_b128 a[88:91], v4 offset:22528
    v_rcp_f32 v63, v63
    ds_read_b128 a[92:95], v4 offset:23552
    v_pk_mul_f32 v[50:51], v[34:35], v[50:51]
    v_pk_mul_f32 v[52:53], v[36:37], v[52:53]
    v_pk_mul_f32 v[54:55], v[38:39], v[54:55]
    v_pk_mul_f32 v[56:57], v[40:41], v[56:57]
    v_pk_mul_f32 v[58:59], v[42:43], v[58:59]
    v_pk_mul_f32 v[60:61], v[44:45], v[60:61]
    v_pk_mul_f32 v[62:63], v[46:47], v[62:63]
    v_pk_mul_f32 v[14:15], v[50:51], v[50:51]
    v_cvt_pk_bf16_f32 v68, v50, v51
    v_pk_fma_f32 v[14:15], v[52:53], v[52:53], v[14:15]
    v_cvt_pk_bf16_f32 v69, v52, v53
    v_pk_fma_f32 v[14:15], v[54:55], v[54:55], v[14:15]
    v_cvt_pk_bf16_f32 v70, v54, v55
    v_pk_fma_f32 v[14:15], v[56:57], v[56:57], v[14:15]
    v_cvt_pk_bf16_f32 v71, v56, v57
    ds_write_b128 v5, v[68:71] offset:13312
    v_pk_fma_f32 v[14:15], v[58:59], v[58:59], v[14:15]
    v_cvt_pk_bf16_f32 v92, v58, v59
    v_pk_fma_f32 v[14:15], v[60:61], v[60:61], v[14:15]
    v_cvt_pk_bf16_f32 v93, v60, v61
    v_pk_fma_f32 v[14:15], v[62:63], v[62:63], v[14:15]
    v_cvt_pk_bf16_f32 v94, v62, v63
    v_pk_fma_f32 v[50:51], v[18:19], v[18:19], s[60:61]
    v_pk_fma_f32 v[52:53], v[20:21], v[20:21], s[60:61]
    buffer_load_dwordx4 v[148:151], v8, s[8:11], 0 offen offset:0
    v_pk_fma_f32 v[54:55], v[22:23], v[22:23], s[60:61]
    v_pk_fma_f32 v[56:57], v[24:25], v[24:25], s[60:61]
    v_pk_fma_f32 v[58:59], v[26:27], v[26:27], s[60:61]
    v_pk_fma_f32 v[60:61], v[28:29], v[28:29], s[60:61]
    v_pk_fma_f32 v[62:63], v[30:31], v[30:31], s[60:61]
    v_pk_mul_f32 v[50:51], v[18:19], v[50:51] neg_lo:[1,0] neg_hi:[1,0]
    v_pk_mul_f32 v[52:53], v[20:21], v[52:53] neg_lo:[1,0] neg_hi:[1,0]
    v_pk_mul_f32 v[54:55], v[22:23], v[54:55] neg_lo:[1,0] neg_hi:[1,0]
    v_pk_mul_f32 v[56:57], v[24:25], v[56:57] neg_lo:[1,0] neg_hi:[1,0]
    v_pk_mul_f32 v[58:59], v[26:27], v[58:59] neg_lo:[1,0] neg_hi:[1,0]
    v_pk_mul_f32 v[60:61], v[28:29], v[60:61] neg_lo:[1,0] neg_hi:[1,0]
    v_pk_mul_f32 v[62:63], v[30:31], v[62:63] neg_lo:[1,0] neg_hi:[1,0]
    s_waitcnt lgkmcnt(6)
    v_mfma_f32_32x32x16_bf16 v[34:49], a[72:75], a[0:3], 0
    v_exp_f32 v50, v50
    v_exp_f32 v51, v51
    v_exp_f32 v52, v52
    s_waitcnt lgkmcnt(5)
    v_mfma_f32_32x32x16_bf16 v[34:49], a[76:79], a[4:7], v[34:49]
    v_exp_f32 v53, v53
    v_exp_f32 v54, v54
    v_exp_f32 v55, v55
    s_waitcnt lgkmcnt(4)
    v_mfma_f32_32x32x16_bf16 v[34:49], a[80:83], a[8:11], v[34:49]
    v_exp_f32 v56, v56
    v_exp_f32 v57, v57
    v_exp_f32 v58, v58
    v_exp_f32 v59, v59
    v_exp_f32 v60, v60
    v_exp_f32 v61, v61
    v_exp_f32 v62, v62
    v_exp_f32 v63, v63
    v_pk_add_f32 v[50:51], v[50:51], 1.0 op_sel_hi:[1,0]
    v_pk_add_f32 v[52:53], v[52:53], 1.0 op_sel_hi:[1,0]
    v_pk_add_f32 v[54:55], v[54:55], 1.0 op_sel_hi:[1,0]
    v_pk_add_f32 v[56:57], v[56:57], 1.0 op_sel_hi:[1,0]
    v_pk_add_f32 v[58:59], v[58:59], 1.0 op_sel_hi:[1,0]
    v_pk_add_f32 v[60:61], v[60:61], 1.0 op_sel_hi:[1,0]
    v_pk_add_f32 v[62:63], v[62:63], 1.0 op_sel_hi:[1,0]
    s_waitcnt lgkmcnt(3)
    v_mfma_f32_32x32x16_bf16 v[34:49], a[84:87], a[12:15], v[34:49]
    v_rcp_f32 v50, v50
    v_rcp_f32 v51, v51
    v_rcp_f32 v52, v52
    s_waitcnt lgkmcnt(2)
    v_mfma_f32_32x32x16_bf16 v[34:49], a[88:91], a[16:19], v[34:49]
    v_rcp_f32 v53, v53
    v_rcp_f32 v54, v54
    v_rcp_f32 v55, v55
    s_waitcnt lgkmcnt(1)
    v_mfma_f32_32x32x16_bf16 v[34:49], a[92:95], a[20:23], v[34:49]
    v_rcp_f32 v56, v56
    v_rcp_f32 v57, v57
    v_rcp_f32 v58, v58
    v_rcp_f32 v59, v59
    v_rcp_f32 v60, v60
    v_rcp_f32 v61, v61
    v_rcp_f32 v62, v62
    v_rcp_f32 v63, v63
    v_pk_mul_f32 v[50:51], v[18:19], v[50:51]
    v_pk_mul_f32 v[52:53], v[20:21], v[52:53]
    v_pk_mul_f32 v[54:55], v[22:23], v[54:55]
    v_pk_mul_f32 v[56:57], v[24:25], v[56:57]
    v_pk_mul_f32 v[58:59], v[26:27], v[58:59]
    v_pk_mul_f32 v[60:61], v[28:29], v[60:61]
    v_pk_mul_f32 v[62:63], v[30:31], v[62:63]
    v_pk_mul_f32 v[16:17], v[50:51], v[50:51]
    v_cvt_pk_bf16_f32 v72, v50, v51
    v_pk_fma_f32 v[16:17], v[52:53], v[52:53], v[16:17]
    v_cvt_pk_bf16_f32 v73, v52, v53
    v_pk_fma_f32 v[16:17], v[54:55], v[54:55], v[16:17]
    v_cvt_pk_bf16_f32 v74, v54, v55
    v_pk_fma_f32 v[16:17], v[56:57], v[56:57], v[16:17]
    v_cvt_pk_bf16_f32 v75, v56, v57
    ds_write_b128 v5, v[72:75] offset:14336
    v_pk_fma_f32 v[16:17], v[58:59], v[58:59], v[16:17]
    v_cvt_pk_bf16_f32 v96, v58, v59
    v_pk_fma_f32 v[16:17], v[60:61], v[60:61], v[16:17]
    v_cvt_pk_bf16_f32 v97, v60, v61
    v_pk_fma_f32 v[16:17], v[62:63], v[62:63], v[16:17]
    v_cvt_pk_bf16_f32 v98, v62, v63
    s_setprio 2
    v_pk_fma_f32 v[50:51], v[34:35], v[34:35], s[60:61]
    v_pk_fma_f32 v[52:53], v[36:37], v[36:37], s[60:61]
    buffer_load_dwordx4 v[128:131], v0, s[8:11], 0 offen offset:64
    v_pk_fma_f32 v[54:55], v[38:39], v[38:39], s[60:61]
    v_pk_fma_f32 v[56:57], v[40:41], v[40:41], s[60:61]
    v_pk_fma_f32 v[58:59], v[42:43], v[42:43], s[60:61]
    v_pk_fma_f32 v[60:61], v[44:45], v[44:45], s[60:61]
    v_pk_fma_f32 v[62:63], v[46:47], v[46:47], s[60:61]
    v_pk_mul_f32 v[50:51], v[34:35], v[50:51] neg_lo:[1,0] neg_hi:[1,0]
    v_pk_mul_f32 v[52:53], v[36:37], v[52:53] neg_lo:[1,0] neg_hi:[1,0]
    v_pk_mul_f32 v[54:55], v[38:39], v[54:55] neg_lo:[1,0] neg_hi:[1,0]
    v_pk_mul_f32 v[56:57], v[40:41], v[56:57] neg_lo:[1,0] neg_hi:[1,0]
    v_pk_mul_f32 v[58:59], v[42:43], v[58:59] neg_lo:[1,0] neg_hi:[1,0]
    v_pk_mul_f32 v[60:61], v[44:45], v[60:61] neg_lo:[1,0] neg_hi:[1,0]
    v_pk_mul_f32 v[62:63], v[46:47], v[62:63] neg_lo:[1,0] neg_hi:[1,0]
    v_mfma_f32_32x32x16_bf16 v[18:33], a[72:75], a[24:27], 0
    v_exp_f32 v50, v50
    v_exp_f32 v51, v51
    v_exp_f32 v52, v52
    v_mfma_f32_32x32x16_bf16 v[18:33], a[76:79], a[28:31], v[18:33]
    v_exp_f32 v53, v53
    v_exp_f32 v54, v54
    v_exp_f32 v55, v55
    v_mfma_f32_32x32x16_bf16 v[18:33], a[80:83], a[32:35], v[18:33]
    v_exp_f32 v56, v56
    v_exp_f32 v57, v57
    v_exp_f32 v58, v58
    v_exp_f32 v59, v59
    v_exp_f32 v60, v60
    v_exp_f32 v61, v61
    v_exp_f32 v62, v62
    v_exp_f32 v63, v63
    v_pk_add_f32 v[50:51], v[50:51], 1.0 op_sel_hi:[1,0]
    v_pk_add_f32 v[52:53], v[52:53], 1.0 op_sel_hi:[1,0]
    v_pk_add_f32 v[54:55], v[54:55], 1.0 op_sel_hi:[1,0]
    v_pk_add_f32 v[56:57], v[56:57], 1.0 op_sel_hi:[1,0]
    v_pk_add_f32 v[58:59], v[58:59], 1.0 op_sel_hi:[1,0]
    v_pk_add_f32 v[60:61], v[60:61], 1.0 op_sel_hi:[1,0]
    v_pk_add_f32 v[62:63], v[62:63], 1.0 op_sel_hi:[1,0]
    v_mfma_f32_32x32x16_bf16 v[18:33], a[84:87], a[36:39], v[18:33]
    v_rcp_f32 v50, v50
    v_rcp_f32 v51, v51
    v_rcp_f32 v52, v52
    v_mfma_f32_32x32x16_bf16 v[18:33], a[88:91], a[40:43], v[18:33]
    v_rcp_f32 v53, v53
    v_rcp_f32 v54, v54
    v_rcp_f32 v55, v55
    v_mfma_f32_32x32x16_bf16 v[18:33], a[92:95], a[44:47], v[18:33]
    v_rcp_f32 v56, v56
    v_rcp_f32 v57, v57
    v_rcp_f32 v58, v58
    v_rcp_f32 v59, v59
    v_rcp_f32 v60, v60
    v_rcp_f32 v61, v61
    v_rcp_f32 v62, v62
    v_rcp_f32 v63, v63
    v_pk_mul_f32 v[50:51], v[34:35], v[50:51]
    v_pk_mul_f32 v[52:53], v[36:37], v[52:53]
    v_pk_mul_f32 v[54:55], v[38:39], v[54:55]
    v_pk_mul_f32 v[56:57], v[40:41], v[56:57]
    v_pk_mul_f32 v[58:59], v[42:43], v[58:59]
    v_pk_mul_f32 v[60:61], v[44:45], v[60:61]
    v_pk_mul_f32 v[62:63], v[46:47], v[62:63]
    v_pk_fma_f32 v[12:13], v[50:51], v[50:51], v[12:13]
    v_cvt_pk_bf16_f32 v64, v50, v51
    v_pk_fma_f32 v[12:13], v[52:53], v[52:53], v[12:13]
    v_cvt_pk_bf16_f32 v65, v52, v53
    v_pk_fma_f32 v[12:13], v[54:55], v[54:55], v[12:13]
    v_cvt_pk_bf16_f32 v66, v54, v55
    v_pk_fma_f32 v[12:13], v[56:57], v[56:57], v[12:13]
    v_cvt_pk_bf16_f32 v67, v56, v57
    ds_write_b128 v6, v[64:67] offset:12288
    v_pk_fma_f32 v[12:13], v[58:59], v[58:59], v[12:13]
    v_cvt_pk_bf16_f32 v91, v58, v59
    ds_write_b128 v6, v[88:91] offset:36864
    v_pk_fma_f32 v[12:13], v[60:61], v[60:61], v[12:13]
    v_cvt_pk_bf16_f32 v100, v60, v61
    v_pk_fma_f32 v[12:13], v[62:63], v[62:63], v[12:13]
    v_cvt_pk_bf16_f32 v101, v62, v63
    v_pk_fma_f32 v[50:51], v[18:19], v[18:19], s[60:61]
    v_pk_fma_f32 v[52:53], v[20:21], v[20:21], s[60:61]
    buffer_load_dwordx4 v[140:143], v1, s[8:11], 0 offen offset:64
    v_pk_fma_f32 v[54:55], v[22:23], v[22:23], s[60:61]
    v_pk_fma_f32 v[56:57], v[24:25], v[24:25], s[60:61]
    v_pk_fma_f32 v[58:59], v[26:27], v[26:27], s[60:61]
    v_pk_fma_f32 v[60:61], v[28:29], v[28:29], s[60:61]
    v_pk_fma_f32 v[62:63], v[30:31], v[30:31], s[60:61]
    v_pk_mul_f32 v[50:51], v[18:19], v[50:51] neg_lo:[1,0] neg_hi:[1,0]
    v_pk_mul_f32 v[52:53], v[20:21], v[52:53] neg_lo:[1,0] neg_hi:[1,0]
    v_pk_mul_f32 v[54:55], v[22:23], v[54:55] neg_lo:[1,0] neg_hi:[1,0]
    v_pk_mul_f32 v[56:57], v[24:25], v[56:57] neg_lo:[1,0] neg_hi:[1,0]
    v_pk_mul_f32 v[58:59], v[26:27], v[58:59] neg_lo:[1,0] neg_hi:[1,0]
    v_pk_mul_f32 v[60:61], v[28:29], v[60:61] neg_lo:[1,0] neg_hi:[1,0]
    v_pk_mul_f32 v[62:63], v[30:31], v[62:63] neg_lo:[1,0] neg_hi:[1,0]
    v_mfma_f32_32x32x16_bf16 v[34:49], a[72:75], a[48:51], 0
    v_exp_f32 v50, v50
    v_exp_f32 v51, v51
    v_exp_f32 v52, v52
    v_mfma_f32_32x32x16_bf16 v[34:49], a[76:79], a[52:55], v[34:49]
    v_exp_f32 v53, v53
    v_exp_f32 v54, v54
    v_exp_f32 v55, v55
    v_mfma_f32_32x32x16_bf16 v[34:49], a[80:83], a[56:59], v[34:49]
    v_exp_f32 v56, v56
    v_exp_f32 v57, v57
    v_exp_f32 v58, v58
    v_exp_f32 v59, v59
    v_exp_f32 v60, v60
    v_exp_f32 v61, v61
    ds_read_b128 a[72:75], v4 offset:6144
    v_exp_f32 v62, v62
    ds_read_b128 a[76:79], v4 offset:7168
    v_exp_f32 v63, v63
    ds_read_b128 a[80:83], v4 offset:8192
    v_pk_add_f32 v[50:51], v[50:51], 1.0 op_sel_hi:[1,0]
    v_pk_add_f32 v[52:53], v[52:53], 1.0 op_sel_hi:[1,0]
    v_pk_add_f32 v[54:55], v[54:55], 1.0 op_sel_hi:[1,0]
    v_pk_add_f32 v[56:57], v[56:57], 1.0 op_sel_hi:[1,0]
    v_pk_add_f32 v[58:59], v[58:59], 1.0 op_sel_hi:[1,0]
    v_pk_add_f32 v[60:61], v[60:61], 1.0 op_sel_hi:[1,0]
    v_pk_add_f32 v[62:63], v[62:63], 1.0 op_sel_hi:[1,0]
    v_mfma_f32_32x32x16_bf16 v[34:49], a[84:87], a[60:63], v[34:49]
    v_rcp_f32 v50, v50
    v_rcp_f32 v51, v51
    v_rcp_f32 v52, v52
    v_mfma_f32_32x32x16_bf16 v[34:49], a[88:91], a[64:67], v[34:49]
    v_rcp_f32 v53, v53
    v_rcp_f32 v54, v54
    v_rcp_f32 v55, v55
    v_mfma_f32_32x32x16_bf16 v[34:49], a[92:95], a[68:71], v[34:49]
    v_rcp_f32 v56, v56
    v_rcp_f32 v57, v57
    v_rcp_f32 v58, v58
    v_rcp_f32 v59, v59
    v_rcp_f32 v60, v60
    v_rcp_f32 v61, v61
    ds_read_b128 a[84:87], v4 offset:9216
    v_rcp_f32 v62, v62
    ds_read_b128 a[88:91], v4 offset:10240
    v_rcp_f32 v63, v63
    ds_read_b128 a[92:95], v4 offset:11264
    v_pk_mul_f32 v[50:51], v[18:19], v[50:51]
    v_pk_mul_f32 v[52:53], v[20:21], v[52:53]
    v_pk_mul_f32 v[54:55], v[22:23], v[54:55]
    v_pk_mul_f32 v[56:57], v[24:25], v[56:57]
    v_pk_mul_f32 v[58:59], v[26:27], v[58:59]
    v_pk_mul_f32 v[60:61], v[28:29], v[60:61]
    v_pk_mul_f32 v[62:63], v[30:31], v[62:63]
    v_pk_fma_f32 v[14:15], v[50:51], v[50:51], v[14:15]
    v_cvt_pk_bf16_f32 v68, v50, v51
    v_pk_fma_f32 v[14:15], v[52:53], v[52:53], v[14:15]
    v_cvt_pk_bf16_f32 v69, v52, v53
    v_pk_fma_f32 v[14:15], v[54:55], v[54:55], v[14:15]
    v_cvt_pk_bf16_f32 v70, v54, v55
    v_pk_fma_f32 v[14:15], v[56:57], v[56:57], v[14:15]
    v_cvt_pk_bf16_f32 v71, v56, v57
    ds_write_b128 v6, v[68:71] offset:13312
    v_pk_fma_f32 v[14:15], v[58:59], v[58:59], v[14:15]
    v_cvt_pk_bf16_f32 v95, v58, v59
    ds_write_b128 v6, v[92:95] offset:37888
    v_pk_fma_f32 v[14:15], v[60:61], v[60:61], v[14:15]
    v_cvt_pk_bf16_f32 v104, v60, v61
    v_pk_fma_f32 v[14:15], v[62:63], v[62:63], v[14:15]
    v_cvt_pk_bf16_f32 v105, v62, v63
    v_pk_fma_f32 v[50:51], v[34:35], v[34:35], s[60:61]
    v_pk_fma_f32 v[52:53], v[36:37], v[36:37], s[60:61]
    buffer_load_dwordx4 v[152:155], v8, s[8:11], 0 offen offset:64
    v_pk_fma_f32 v[54:55], v[38:39], v[38:39], s[60:61]
    v_pk_fma_f32 v[56:57], v[40:41], v[40:41], s[60:61]
    v_pk_fma_f32 v[58:59], v[42:43], v[42:43], s[60:61]
    v_pk_fma_f32 v[60:61], v[44:45], v[44:45], s[60:61]
    v_pk_fma_f32 v[62:63], v[46:47], v[46:47], s[60:61]
    v_pk_mul_f32 v[50:51], v[34:35], v[50:51] neg_lo:[1,0] neg_hi:[1,0]
    v_pk_mul_f32 v[52:53], v[36:37], v[52:53] neg_lo:[1,0] neg_hi:[1,0]
    v_pk_mul_f32 v[54:55], v[38:39], v[54:55] neg_lo:[1,0] neg_hi:[1,0]
    v_pk_mul_f32 v[56:57], v[40:41], v[56:57] neg_lo:[1,0] neg_hi:[1,0]
    v_pk_mul_f32 v[58:59], v[42:43], v[58:59] neg_lo:[1,0] neg_hi:[1,0]
    v_pk_mul_f32 v[60:61], v[44:45], v[60:61] neg_lo:[1,0] neg_hi:[1,0]
    v_pk_mul_f32 v[62:63], v[46:47], v[62:63] neg_lo:[1,0] neg_hi:[1,0]
    s_waitcnt lgkmcnt(7)
    v_mfma_f32_32x32x16_bf16 v[18:33], a[72:75], a[0:3], 0
    v_exp_f32 v50, v50
    v_exp_f32 v51, v51
    v_exp_f32 v52, v52
    s_waitcnt lgkmcnt(6)
    v_mfma_f32_32x32x16_bf16 v[18:33], a[76:79], a[4:7], v[18:33]
    v_exp_f32 v53, v53
    v_exp_f32 v54, v54
    v_exp_f32 v55, v55
    s_waitcnt lgkmcnt(5)
    v_mfma_f32_32x32x16_bf16 v[18:33], a[80:83], a[8:11], v[18:33]
    v_exp_f32 v56, v56
    v_exp_f32 v57, v57
    v_exp_f32 v58, v58
    v_exp_f32 v59, v59
    v_exp_f32 v60, v60
    v_exp_f32 v61, v61
    v_exp_f32 v62, v62
    v_exp_f32 v63, v63
    v_pk_add_f32 v[50:51], v[50:51], 1.0 op_sel_hi:[1,0]
    v_pk_add_f32 v[52:53], v[52:53], 1.0 op_sel_hi:[1,0]
    v_pk_add_f32 v[54:55], v[54:55], 1.0 op_sel_hi:[1,0]
    v_pk_add_f32 v[56:57], v[56:57], 1.0 op_sel_hi:[1,0]
    v_pk_add_f32 v[58:59], v[58:59], 1.0 op_sel_hi:[1,0]
    v_pk_add_f32 v[60:61], v[60:61], 1.0 op_sel_hi:[1,0]
    v_pk_add_f32 v[62:63], v[62:63], 1.0 op_sel_hi:[1,0]
    s_waitcnt lgkmcnt(4)
    v_mfma_f32_32x32x16_bf16 v[18:33], a[84:87], a[12:15], v[18:33]
    v_rcp_f32 v50, v50
    v_rcp_f32 v51, v51
    v_rcp_f32 v52, v52
    s_waitcnt lgkmcnt(3)
    v_mfma_f32_32x32x16_bf16 v[18:33], a[88:91], a[16:19], v[18:33]
    v_rcp_f32 v53, v53
    v_rcp_f32 v54, v54
    v_rcp_f32 v55, v55
    s_waitcnt lgkmcnt(2)
    v_mfma_f32_32x32x16_bf16 v[18:33], a[92:95], a[20:23], v[18:33]
    v_rcp_f32 v56, v56
    v_rcp_f32 v57, v57
    v_rcp_f32 v58, v58
    v_rcp_f32 v59, v59
    v_rcp_f32 v60, v60
    v_rcp_f32 v61, v61
    v_rcp_f32 v62, v62
    v_rcp_f32 v63, v63
    v_pk_mul_f32 v[50:51], v[34:35], v[50:51]
    v_pk_mul_f32 v[52:53], v[36:37], v[52:53]
    v_pk_mul_f32 v[54:55], v[38:39], v[54:55]
    v_pk_mul_f32 v[56:57], v[40:41], v[56:57]
    v_pk_mul_f32 v[58:59], v[42:43], v[58:59]
    v_pk_mul_f32 v[60:61], v[44:45], v[60:61]
    v_pk_mul_f32 v[62:63], v[46:47], v[62:63]
    v_pk_fma_f32 v[16:17], v[50:51], v[50:51], v[16:17]
    v_cvt_pk_bf16_f32 v72, v50, v51
    v_pk_fma_f32 v[16:17], v[52:53], v[52:53], v[16:17]
    v_cvt_pk_bf16_f32 v73, v52, v53
    v_pk_fma_f32 v[16:17], v[54:55], v[54:55], v[16:17]
    v_cvt_pk_bf16_f32 v74, v54, v55
    v_pk_fma_f32 v[16:17], v[56:57], v[56:57], v[16:17]
    v_cvt_pk_bf16_f32 v75, v56, v57
    ds_write_b128 v6, v[72:75] offset:14336
    v_pk_fma_f32 v[16:17], v[58:59], v[58:59], v[16:17]
    v_cvt_pk_bf16_f32 v99, v58, v59
    ds_write_b128 v6, v[96:99] offset:38912
    v_pk_fma_f32 v[16:17], v[60:61], v[60:61], v[16:17]
    v_cvt_pk_bf16_f32 v108, v60, v61
    v_pk_fma_f32 v[16:17], v[62:63], v[62:63], v[16:17]
    v_cvt_pk_bf16_f32 v109, v62, v63
    s_setprio 1
    v_pk_fma_f32 v[50:51], v[18:19], v[18:19], s[60:61]
    v_pk_fma_f32 v[52:53], v[20:21], v[20:21], s[60:61]
    buffer_load_dwordx4 v[132:135], v0, s[8:11], 0 offen offset:128
    v_pk_fma_f32 v[54:55], v[22:23], v[22:23], s[60:61]
    v_pk_fma_f32 v[56:57], v[24:25], v[24:25], s[60:61]
    v_pk_fma_f32 v[58:59], v[26:27], v[26:27], s[60:61]
    v_pk_fma_f32 v[60:61], v[28:29], v[28:29], s[60:61]
    v_pk_fma_f32 v[62:63], v[30:31], v[30:31], s[60:61]
    v_pk_mul_f32 v[50:51], v[18:19], v[50:51] neg_lo:[1,0] neg_hi:[1,0]
    v_pk_mul_f32 v[52:53], v[20:21], v[52:53] neg_lo:[1,0] neg_hi:[1,0]
    v_pk_mul_f32 v[54:55], v[22:23], v[54:55] neg_lo:[1,0] neg_hi:[1,0]
    v_pk_mul_f32 v[56:57], v[24:25], v[56:57] neg_lo:[1,0] neg_hi:[1,0]
    v_pk_mul_f32 v[58:59], v[26:27], v[58:59] neg_lo:[1,0] neg_hi:[1,0]
    v_pk_mul_f32 v[60:61], v[28:29], v[60:61] neg_lo:[1,0] neg_hi:[1,0]
    v_pk_mul_f32 v[62:63], v[30:31], v[62:63] neg_lo:[1,0] neg_hi:[1,0]
    v_mfma_f32_32x32x16_bf16 v[34:49], a[72:75], a[24:27], 0
    v_exp_f32 v50, v50
    v_exp_f32 v51, v51
    v_exp_f32 v52, v52
    v_mfma_f32_32x32x16_bf16 v[34:49], a[76:79], a[28:31], v[34:49]
    v_exp_f32 v53, v53
    v_exp_f32 v54, v54
    v_exp_f32 v55, v55
    v_mfma_f32_32x32x16_bf16 v[34:49], a[80:83], a[32:35], v[34:49]
    v_exp_f32 v56, v56
    v_exp_f32 v57, v57
    v_exp_f32 v58, v58
    v_exp_f32 v59, v59
    v_exp_f32 v60, v60
    v_exp_f32 v61, v61
    v_exp_f32 v62, v62
    v_exp_f32 v63, v63
    v_pk_add_f32 v[50:51], v[50:51], 1.0 op_sel_hi:[1,0]
    v_pk_add_f32 v[52:53], v[52:53], 1.0 op_sel_hi:[1,0]
    v_pk_add_f32 v[54:55], v[54:55], 1.0 op_sel_hi:[1,0]
    v_pk_add_f32 v[56:57], v[56:57], 1.0 op_sel_hi:[1,0]
    v_pk_add_f32 v[58:59], v[58:59], 1.0 op_sel_hi:[1,0]
    v_pk_add_f32 v[60:61], v[60:61], 1.0 op_sel_hi:[1,0]
    v_pk_add_f32 v[62:63], v[62:63], 1.0 op_sel_hi:[1,0]
    v_mfma_f32_32x32x16_bf16 v[34:49], a[84:87], a[36:39], v[34:49]
    v_rcp_f32 v50, v50
    v_rcp_f32 v51, v51
    v_rcp_f32 v52, v52
    v_mfma_f32_32x32x16_bf16 v[34:49], a[88:91], a[40:43], v[34:49]
    v_rcp_f32 v53, v53
    v_rcp_f32 v54, v54
    v_rcp_f32 v55, v55
    v_mfma_f32_32x32x16_bf16 v[34:49], a[92:95], a[44:47], v[34:49]
    v_rcp_f32 v56, v56
    v_rcp_f32 v57, v57
    v_rcp_f32 v58, v58
    v_rcp_f32 v59, v59
    v_rcp_f32 v60, v60
    v_rcp_f32 v61, v61
    v_rcp_f32 v62, v62
    v_rcp_f32 v63, v63
    v_pk_mul_f32 v[50:51], v[18:19], v[50:51]
    v_pk_mul_f32 v[52:53], v[20:21], v[52:53]
    v_pk_mul_f32 v[54:55], v[22:23], v[54:55]
    v_pk_mul_f32 v[56:57], v[24:25], v[56:57]
    v_pk_mul_f32 v[58:59], v[26:27], v[58:59]
    v_pk_mul_f32 v[60:61], v[28:29], v[60:61]
    v_pk_mul_f32 v[62:63], v[30:31], v[62:63]
    v_pk_fma_f32 v[12:13], v[50:51], v[50:51], v[12:13]
    v_cvt_pk_bf16_f32 v64, v50, v51
    v_pk_fma_f32 v[12:13], v[52:53], v[52:53], v[12:13]
    v_cvt_pk_bf16_f32 v65, v52, v53
    v_pk_fma_f32 v[12:13], v[54:55], v[54:55], v[12:13]
    v_cvt_pk_bf16_f32 v66, v54, v55
    v_pk_fma_f32 v[12:13], v[56:57], v[56:57], v[12:13]
    v_cvt_pk_bf16_f32 v67, v56, v57
    ds_write_b128 v6, v[64:67] offset:0
    v_pk_fma_f32 v[12:13], v[58:59], v[58:59], v[12:13]
    v_cvt_pk_bf16_f32 v102, v58, v59
    v_pk_fma_f32 v[12:13], v[60:61], v[60:61], v[12:13]
    v_cvt_pk_bf16_f32 v103, v60, v61
    ds_write_b128 v6, v[100:103] offset:49152
    v_pk_fma_f32 v[12:13], v[62:63], v[62:63], v[12:13]
    v_cvt_pk_bf16_f32 v76, v62, v63
    v_add_u32 v4, 122880, v4
    v_pk_fma_f32 v[50:51], v[34:35], v[34:35], s[60:61]
    v_pk_fma_f32 v[52:53], v[36:37], v[36:37], s[60:61]
    buffer_load_dwordx4 v[144:147], v1, s[8:11], 0 offen offset:128
    v_pk_fma_f32 v[54:55], v[38:39], v[38:39], s[60:61]
    v_pk_fma_f32 v[56:57], v[40:41], v[40:41], s[60:61]
    v_pk_fma_f32 v[58:59], v[42:43], v[42:43], s[60:61]
    v_pk_fma_f32 v[60:61], v[44:45], v[44:45], s[60:61]
    v_pk_fma_f32 v[62:63], v[46:47], v[46:47], s[60:61]
    v_pk_mul_f32 v[50:51], v[34:35], v[50:51] neg_lo:[1,0] neg_hi:[1,0]
    v_pk_mul_f32 v[52:53], v[36:37], v[52:53] neg_lo:[1,0] neg_hi:[1,0]
    v_pk_mul_f32 v[54:55], v[38:39], v[54:55] neg_lo:[1,0] neg_hi:[1,0]
    v_pk_mul_f32 v[56:57], v[40:41], v[56:57] neg_lo:[1,0] neg_hi:[1,0]
    v_pk_mul_f32 v[58:59], v[42:43], v[58:59] neg_lo:[1,0] neg_hi:[1,0]
    v_pk_mul_f32 v[60:61], v[44:45], v[60:61] neg_lo:[1,0] neg_hi:[1,0]
    v_pk_mul_f32 v[62:63], v[46:47], v[62:63] neg_lo:[1,0] neg_hi:[1,0]
    v_mfma_f32_32x32x16_bf16 v[18:33], a[72:75], a[48:51], 0
    v_exp_f32 v50, v50
    v_exp_f32 v51, v51
    v_exp_f32 v52, v52
    v_mfma_f32_32x32x16_bf16 v[18:33], a[76:79], a[52:55], v[18:33]
    v_exp_f32 v53, v53
    v_exp_f32 v54, v54
    v_exp_f32 v55, v55
    v_mfma_f32_32x32x16_bf16 v[18:33], a[80:83], a[56:59], v[18:33]
    v_exp_f32 v56, v56
    v_exp_f32 v57, v57
    v_exp_f32 v58, v58
    v_exp_f32 v59, v59
    v_exp_f32 v60, v60
    v_exp_f32 v61, v61
    ds_read_b128 a[72:75], v4 offset:0
    v_exp_f32 v62, v62
    ds_read_b128 a[76:79], v4 offset:1024
    v_exp_f32 v63, v63
    ds_read_b128 a[80:83], v4 offset:2048
    v_pk_add_f32 v[50:51], v[50:51], 1.0 op_sel_hi:[1,0]
    v_pk_add_f32 v[52:53], v[52:53], 1.0 op_sel_hi:[1,0]
    v_pk_add_f32 v[54:55], v[54:55], 1.0 op_sel_hi:[1,0]
    v_pk_add_f32 v[56:57], v[56:57], 1.0 op_sel_hi:[1,0]
    v_pk_add_f32 v[58:59], v[58:59], 1.0 op_sel_hi:[1,0]
    v_pk_add_f32 v[60:61], v[60:61], 1.0 op_sel_hi:[1,0]
    v_pk_add_f32 v[62:63], v[62:63], 1.0 op_sel_hi:[1,0]
    v_mfma_f32_32x32x16_bf16 v[18:33], a[84:87], a[60:63], v[18:33]
    v_rcp_f32 v50, v50
    v_rcp_f32 v51, v51
    v_rcp_f32 v52, v52
    v_mfma_f32_32x32x16_bf16 v[18:33], a[88:91], a[64:67], v[18:33]
    v_rcp_f32 v53, v53
    v_rcp_f32 v54, v54
    v_rcp_f32 v55, v55
    v_mfma_f32_32x32x16_bf16 v[18:33], a[92:95], a[68:71], v[18:33]
    v_rcp_f32 v56, v56
    v_rcp_f32 v57, v57
    v_rcp_f32 v58, v58
    v_rcp_f32 v59, v59
    v_rcp_f32 v60, v60
    v_rcp_f32 v61, v61
    ds_read_b128 a[84:87], v4 offset:3072
    v_rcp_f32 v62, v62
    ds_read_b128 a[88:91], v4 offset:4096
    v_rcp_f32 v63, v63
    ds_read_b128 a[92:95], v4 offset:5120
    v_pk_mul_f32 v[50:51], v[34:35], v[50:51]
    v_pk_mul_f32 v[52:53], v[36:37], v[52:53]
    v_pk_mul_f32 v[54:55], v[38:39], v[54:55]
    v_pk_mul_f32 v[56:57], v[40:41], v[56:57]
    v_pk_mul_f32 v[58:59], v[42:43], v[58:59]
    v_pk_mul_f32 v[60:61], v[44:45], v[60:61]
    v_pk_mul_f32 v[62:63], v[46:47], v[62:63]
    v_pk_fma_f32 v[14:15], v[50:51], v[50:51], v[14:15]
    v_cvt_pk_bf16_f32 v68, v50, v51
    v_pk_fma_f32 v[14:15], v[52:53], v[52:53], v[14:15]
    v_cvt_pk_bf16_f32 v69, v52, v53
    v_pk_fma_f32 v[14:15], v[54:55], v[54:55], v[14:15]
    v_cvt_pk_bf16_f32 v70, v54, v55
    v_pk_fma_f32 v[14:15], v[56:57], v[56:57], v[14:15]
    v_cvt_pk_bf16_f32 v71, v56, v57
    ds_write_b128 v6, v[68:71] offset:1024
    v_pk_fma_f32 v[14:15], v[58:59], v[58:59], v[14:15]
    v_cvt_pk_bf16_f32 v106, v58, v59
    v_pk_fma_f32 v[14:15], v[60:61], v[60:61], v[14:15]
    v_cvt_pk_bf16_f32 v107, v60, v61
    ds_write_b128 v6, v[104:107] offset:50176
    v_pk_fma_f32 v[14:15], v[62:63], v[62:63], v[14:15]
    v_cvt_pk_bf16_f32 v80, v62, v63
    v_pk_fma_f32 v[50:51], v[18:19], v[18:19], s[60:61]
    v_pk_fma_f32 v[52:53], v[20:21], v[20:21], s[60:61]
    buffer_load_dwordx4 v[156:159], v8, s[8:11], 0 offen offset:128
    v_pk_fma_f32 v[54:55], v[22:23], v[22:23], s[60:61]
    v_pk_fma_f32 v[56:57], v[24:25], v[24:25], s[60:61]
    v_pk_fma_f32 v[58:59], v[26:27], v[26:27], s[60:61]
    v_pk_fma_f32 v[60:61], v[28:29], v[28:29], s[60:61]
    v_pk_fma_f32 v[62:63], v[30:31], v[30:31], s[60:61]
    v_pk_mul_f32 v[50:51], v[18:19], v[50:51] neg_lo:[1,0] neg_hi:[1,0]
    v_pk_mul_f32 v[52:53], v[20:21], v[52:53] neg_lo:[1,0] neg_hi:[1,0]
    v_pk_mul_f32 v[54:55], v[22:23], v[54:55] neg_lo:[1,0] neg_hi:[1,0]
    v_pk_mul_f32 v[56:57], v[24:25], v[56:57] neg_lo:[1,0] neg_hi:[1,0]
    v_pk_mul_f32 v[58:59], v[26:27], v[58:59] neg_lo:[1,0] neg_hi:[1,0]
    v_pk_mul_f32 v[60:61], v[28:29], v[60:61] neg_lo:[1,0] neg_hi:[1,0]
    v_pk_mul_f32 v[62:63], v[30:31], v[62:63] neg_lo:[1,0] neg_hi:[1,0]
    s_waitcnt lgkmcnt(7)
    v_mfma_f32_32x32x16_bf16 v[34:49], a[72:75], a[0:3], 0
    v_exp_f32 v50, v50
    v_exp_f32 v51, v51
    v_exp_f32 v52, v52
    s_waitcnt lgkmcnt(6)
    v_mfma_f32_32x32x16_bf16 v[34:49], a[76:79], a[4:7], v[34:49]
    v_exp_f32 v53, v53
    v_exp_f32 v54, v54
    v_exp_f32 v55, v55
    s_waitcnt lgkmcnt(5)
    v_mfma_f32_32x32x16_bf16 v[34:49], a[80:83], a[8:11], v[34:49]
    v_exp_f32 v56, v56
    v_exp_f32 v57, v57
    v_exp_f32 v58, v58
    v_exp_f32 v59, v59
    v_exp_f32 v60, v60
    v_exp_f32 v61, v61
    v_exp_f32 v62, v62
    v_exp_f32 v63, v63
    v_pk_add_f32 v[50:51], v[50:51], 1.0 op_sel_hi:[1,0]
    v_pk_add_f32 v[52:53], v[52:53], 1.0 op_sel_hi:[1,0]
    v_pk_add_f32 v[54:55], v[54:55], 1.0 op_sel_hi:[1,0]
    v_pk_add_f32 v[56:57], v[56:57], 1.0 op_sel_hi:[1,0]
    v_pk_add_f32 v[58:59], v[58:59], 1.0 op_sel_hi:[1,0]
    v_pk_add_f32 v[60:61], v[60:61], 1.0 op_sel_hi:[1,0]
    v_pk_add_f32 v[62:63], v[62:63], 1.0 op_sel_hi:[1,0]
    s_waitcnt lgkmcnt(4)
    v_mfma_f32_32x32x16_bf16 v[34:49], a[84:87], a[12:15], v[34:49]
    v_rcp_f32 v50, v50
    v_rcp_f32 v51, v51
    v_rcp_f32 v52, v52
    s_waitcnt lgkmcnt(3)
    v_mfma_f32_32x32x16_bf16 v[34:49], a[88:91], a[16:19], v[34:49]
    v_rcp_f32 v53, v53
    v_rcp_f32 v54, v54
    v_rcp_f32 v55, v55
    s_waitcnt lgkmcnt(2)
    v_mfma_f32_32x32x16_bf16 v[34:49], a[92:95], a[20:23], v[34:49]
    v_rcp_f32 v56, v56
    v_rcp_f32 v57, v57
    v_rcp_f32 v58, v58
    v_rcp_f32 v59, v59
    v_rcp_f32 v60, v60
    v_rcp_f32 v61, v61
    v_rcp_f32 v62, v62
    v_rcp_f32 v63, v63
    v_pk_mul_f32 v[50:51], v[18:19], v[50:51]
    v_pk_mul_f32 v[52:53], v[20:21], v[52:53]
    v_pk_mul_f32 v[54:55], v[22:23], v[54:55]
    v_pk_mul_f32 v[56:57], v[24:25], v[56:57]
    v_pk_mul_f32 v[58:59], v[26:27], v[58:59]
    v_pk_mul_f32 v[60:61], v[28:29], v[60:61]
    v_pk_mul_f32 v[62:63], v[30:31], v[62:63]
    v_pk_fma_f32 v[16:17], v[50:51], v[50:51], v[16:17]
    v_cvt_pk_bf16_f32 v72, v50, v51
    v_pk_fma_f32 v[16:17], v[52:53], v[52:53], v[16:17]
    v_cvt_pk_bf16_f32 v73, v52, v53
    v_pk_fma_f32 v[16:17], v[54:55], v[54:55], v[16:17]
    v_cvt_pk_bf16_f32 v74, v54, v55
    v_pk_fma_f32 v[16:17], v[56:57], v[56:57], v[16:17]
    v_cvt_pk_bf16_f32 v75, v56, v57
    ds_write_b128 v6, v[72:75] offset:2048
    v_pk_fma_f32 v[16:17], v[58:59], v[58:59], v[16:17]
    v_cvt_pk_bf16_f32 v110, v58, v59
    v_pk_fma_f32 v[16:17], v[60:61], v[60:61], v[16:17]
    v_cvt_pk_bf16_f32 v111, v60, v61
    ds_write_b128 v6, v[108:111] offset:51200
    v_pk_fma_f32 v[16:17], v[62:63], v[62:63], v[16:17]
    v_cvt_pk_bf16_f32 v84, v62, v63
    v_pk_fma_f32 v[50:51], v[34:35], v[34:35], s[60:61]
    s_waitcnt lgkmcnt(0)
    buffer_load_dword v11, off, s[36:39], 0 sc1
    v_pk_fma_f32 v[52:53], v[36:37], v[36:37], s[60:61]
    v_pk_fma_f32 v[54:55], v[38:39], v[38:39], s[60:61]
    v_pk_fma_f32 v[56:57], v[40:41], v[40:41], s[60:61]
    v_pk_fma_f32 v[58:59], v[42:43], v[42:43], s[60:61]
    v_pk_fma_f32 v[60:61], v[44:45], v[44:45], s[60:61]
    v_pk_fma_f32 v[62:63], v[46:47], v[46:47], s[60:61]
    v_pk_mul_f32 v[50:51], v[34:35], v[50:51] neg_lo:[1,0] neg_hi:[1,0]
    v_pk_mul_f32 v[52:53], v[36:37], v[52:53] neg_lo:[1,0] neg_hi:[1,0]
    v_pk_mul_f32 v[54:55], v[38:39], v[54:55] neg_lo:[1,0] neg_hi:[1,0]
    v_pk_mul_f32 v[56:57], v[40:41], v[56:57] neg_lo:[1,0] neg_hi:[1,0]
    v_pk_mul_f32 v[58:59], v[42:43], v[58:59] neg_lo:[1,0] neg_hi:[1,0]
    v_pk_mul_f32 v[60:61], v[44:45], v[60:61] neg_lo:[1,0] neg_hi:[1,0]
    v_pk_mul_f32 v[62:63], v[46:47], v[62:63] neg_lo:[1,0] neg_hi:[1,0]
    v_mfma_f32_32x32x16_bf16 v[18:33], a[72:75], a[24:27], 0
    v_exp_f32 v50, v50
    v_exp_f32 v51, v51
    v_exp_f32 v52, v52
    v_mfma_f32_32x32x16_bf16 v[18:33], a[76:79], a[28:31], v[18:33]
    v_exp_f32 v53, v53
    v_exp_f32 v54, v54
    v_exp_f32 v55, v55
    v_mfma_f32_32x32x16_bf16 v[18:33], a[80:83], a[32:35], v[18:33]
    v_exp_f32 v56, v56
    v_exp_f32 v57, v57
    v_exp_f32 v58, v58
    v_exp_f32 v59, v59
    v_exp_f32 v60, v60
    v_exp_f32 v61, v61
    v_exp_f32 v62, v62
    v_exp_f32 v63, v63
    v_pk_add_f32 v[50:51], v[50:51], 1.0 op_sel_hi:[1,0]
    v_pk_add_f32 v[52:53], v[52:53], 1.0 op_sel_hi:[1,0]
    v_pk_add_f32 v[54:55], v[54:55], 1.0 op_sel_hi:[1,0]
    v_pk_add_f32 v[56:57], v[56:57], 1.0 op_sel_hi:[1,0]
    v_pk_add_f32 v[58:59], v[58:59], 1.0 op_sel_hi:[1,0]
    v_pk_add_f32 v[60:61], v[60:61], 1.0 op_sel_hi:[1,0]
    v_pk_add_f32 v[62:63], v[62:63], 1.0 op_sel_hi:[1,0]
    v_mfma_f32_32x32x16_bf16 v[18:33], a[84:87], a[36:39], v[18:33]
    v_rcp_f32 v50, v50
    v_rcp_f32 v51, v51
    v_rcp_f32 v52, v52
    v_mfma_f32_32x32x16_bf16 v[18:33], a[88:91], a[40:43], v[18:33]
    v_rcp_f32 v53, v53
    v_rcp_f32 v54, v54
    v_rcp_f32 v55, v55
    v_mfma_f32_32x32x16_bf16 v[18:33], a[92:95], a[44:47], v[18:33]
    v_rcp_f32 v56, v56
    v_rcp_f32 v57, v57
    v_rcp_f32 v58, v58
    v_rcp_f32 v59, v59
    v_rcp_f32 v60, v60
    v_rcp_f32 v61, v61
    v_rcp_f32 v62, v62
    v_rcp_f32 v63, v63
    v_pk_mul_f32 v[50:51], v[34:35], v[50:51]
    v_pk_mul_f32 v[52:53], v[36:37], v[52:53]
    v_pk_mul_f32 v[54:55], v[38:39], v[54:55]
    v_pk_mul_f32 v[56:57], v[40:41], v[56:57]
    v_pk_mul_f32 v[58:59], v[42:43], v[58:59]
    v_pk_mul_f32 v[60:61], v[44:45], v[60:61]
    v_pk_mul_f32 v[62:63], v[46:47], v[62:63]
    v_pk_fma_f32 v[12:13], v[50:51], v[50:51], v[12:13]
    v_cvt_pk_bf16_f32 v64, v50, v51
    v_pk_fma_f32 v[12:13], v[52:53], v[52:53], v[12:13]
    v_cvt_pk_bf16_f32 v65, v52, v53
    v_pk_fma_f32 v[12:13], v[54:55], v[54:55], v[12:13]
    v_cvt_pk_bf16_f32 v66, v54, v55
    v_pk_fma_f32 v[12:13], v[56:57], v[56:57], v[12:13]
    v_cvt_pk_bf16_f32 v67, v56, v57
    v_pk_fma_f32 v[12:13], v[58:59], v[58:59], v[12:13]
    v_cvt_pk_bf16_f32 v77, v58, v59
    v_pk_fma_f32 v[12:13], v[60:61], v[60:61], v[12:13]
    v_cvt_pk_bf16_f32 v78, v60, v61
    v_pk_fma_f32 v[12:13], v[62:63], v[62:63], v[12:13]
    v_cvt_pk_bf16_f32 v79, v62, v63
    s_setprio 0
    v_pk_fma_f32 v[50:51], v[18:19], v[18:19], s[60:61]
    v_pk_fma_f32 v[52:53], v[20:21], v[20:21], s[60:61]
    v_pk_fma_f32 v[54:55], v[22:23], v[22:23], s[60:61]
    v_pk_fma_f32 v[56:57], v[24:25], v[24:25], s[60:61]
    v_pk_fma_f32 v[58:59], v[26:27], v[26:27], s[60:61]
    v_pk_fma_f32 v[60:61], v[28:29], v[28:29], s[60:61]
    v_pk_fma_f32 v[62:63], v[30:31], v[30:31], s[60:61]
    v_pk_mul_f32 v[50:51], v[18:19], v[50:51] neg_lo:[1,0] neg_hi:[1,0]
    v_pk_mul_f32 v[52:53], v[20:21], v[52:53] neg_lo:[1,0] neg_hi:[1,0]
    v_pk_mul_f32 v[54:55], v[22:23], v[54:55] neg_lo:[1,0] neg_hi:[1,0]
    v_pk_mul_f32 v[56:57], v[24:25], v[56:57] neg_lo:[1,0] neg_hi:[1,0]
    v_pk_mul_f32 v[58:59], v[26:27], v[58:59] neg_lo:[1,0] neg_hi:[1,0]
    v_pk_mul_f32 v[60:61], v[28:29], v[60:61] neg_lo:[1,0] neg_hi:[1,0]
    v_pk_mul_f32 v[62:63], v[30:31], v[62:63] neg_lo:[1,0] neg_hi:[1,0]
    v_mfma_f32_32x32x16_bf16 v[34:49], a[72:75], a[48:51], 0
    v_exp_f32 v50, v50
    v_exp_f32 v51, v51
    v_exp_f32 v52, v52
    v_mfma_f32_32x32x16_bf16 v[34:49], a[76:79], a[52:55], v[34:49]
    v_exp_f32 v53, v53
    v_exp_f32 v54, v54
    v_exp_f32 v55, v55
    v_mfma_f32_32x32x16_bf16 v[34:49], a[80:83], a[56:59], v[34:49]
    v_exp_f32 v56, v56
    v_exp_f32 v57, v57
    v_exp_f32 v58, v58
    v_exp_f32 v59, v59
    v_exp_f32 v60, v60
    v_exp_f32 v61, v61
    v_exp_f32 v62, v62
    v_exp_f32 v63, v63
    v_pk_add_f32 v[50:51], v[50:51], 1.0 op_sel_hi:[1,0]
    v_pk_add_f32 v[52:53], v[52:53], 1.0 op_sel_hi:[1,0]
    v_pk_add_f32 v[54:55], v[54:55], 1.0 op_sel_hi:[1,0]
    v_pk_add_f32 v[56:57], v[56:57], 1.0 op_sel_hi:[1,0]
    v_pk_add_f32 v[58:59], v[58:59], 1.0 op_sel_hi:[1,0]
    v_pk_add_f32 v[60:61], v[60:61], 1.0 op_sel_hi:[1,0]
    v_pk_add_f32 v[62:63], v[62:63], 1.0 op_sel_hi:[1,0]
    v_mfma_f32_32x32x16_bf16 v[34:49], a[84:87], a[60:63], v[34:49]
    v_rcp_f32 v50, v50
    v_rcp_f32 v51, v51
    v_rcp_f32 v52, v52
    v_mfma_f32_32x32x16_bf16 v[34:49], a[88:91], a[64:67], v[34:49]
    v_rcp_f32 v53, v53
    v_rcp_f32 v54, v54
    v_rcp_f32 v55, v55
    v_mfma_f32_32x32x16_bf16 v[34:49], a[92:95], a[68:71], v[34:49]
    v_rcp_f32 v56, v56
    v_rcp_f32 v57, v57
    v_rcp_f32 v58, v58
    v_rcp_f32 v59, v59
    v_rcp_f32 v60, v60
    v_rcp_f32 v61, v61
    v_rcp_f32 v62, v62
    v_rcp_f32 v63, v63
    v_pk_mul_f32 v[50:51], v[18:19], v[50:51]
    v_pk_mul_f32 v[52:53], v[20:21], v[52:53]
    v_pk_mul_f32 v[54:55], v[22:23], v[54:55]
    v_pk_mul_f32 v[56:57], v[24:25], v[56:57]
    v_pk_mul_f32 v[58:59], v[26:27], v[58:59]
    v_pk_mul_f32 v[60:61], v[28:29], v[60:61]
    v_pk_mul_f32 v[62:63], v[30:31], v[62:63]
    v_pk_fma_f32 v[14:15], v[50:51], v[50:51], v[14:15]
    v_cvt_pk_bf16_f32 v68, v50, v51
    v_pk_fma_f32 v[14:15], v[52:53], v[52:53], v[14:15]
    v_cvt_pk_bf16_f32 v69, v52, v53
    v_pk_fma_f32 v[14:15], v[54:55], v[54:55], v[14:15]
    v_cvt_pk_bf16_f32 v70, v54, v55
    v_pk_fma_f32 v[14:15], v[56:57], v[56:57], v[14:15]
    v_cvt_pk_bf16_f32 v71, v56, v57
    v_pk_fma_f32 v[14:15], v[58:59], v[58:59], v[14:15]
    v_cvt_pk_bf16_f32 v81, v58, v59
    v_pk_fma_f32 v[14:15], v[60:61], v[60:61], v[14:15]
    v_cvt_pk_bf16_f32 v82, v60, v61
    v_pk_fma_f32 v[14:15], v[62:63], v[62:63], v[14:15]
    v_cvt_pk_bf16_f32 v83, v62, v63
    v_pk_fma_f32 v[50:51], v[34:35], v[34:35], s[60:61]
    v_pk_fma_f32 v[52:53], v[36:37], v[36:37], s[60:61]
    v_pk_fma_f32 v[54:55], v[38:39], v[38:39], s[60:61]
    v_pk_fma_f32 v[56:57], v[40:41], v[40:41], s[60:61]
    v_pk_fma_f32 v[58:59], v[42:43], v[42:43], s[60:61]
    v_pk_fma_f32 v[60:61], v[44:45], v[44:45], s[60:61]
    v_pk_fma_f32 v[62:63], v[46:47], v[46:47], s[60:61]
    v_pk_mul_f32 v[50:51], v[34:35], v[50:51] neg_lo:[1,0] neg_hi:[1,0]
    v_pk_mul_f32 v[52:53], v[36:37], v[52:53] neg_lo:[1,0] neg_hi:[1,0]
    v_pk_mul_f32 v[54:55], v[38:39], v[54:55] neg_lo:[1,0] neg_hi:[1,0]
    v_pk_mul_f32 v[56:57], v[40:41], v[56:57] neg_lo:[1,0] neg_hi:[1,0]
    v_pk_mul_f32 v[58:59], v[42:43], v[58:59] neg_lo:[1,0] neg_hi:[1,0]
    v_pk_mul_f32 v[60:61], v[44:45], v[60:61] neg_lo:[1,0] neg_hi:[1,0]
    v_pk_mul_f32 v[62:63], v[46:47], v[62:63] neg_lo:[1,0] neg_hi:[1,0]
    v_exp_f32 v50, v50
    v_exp_f32 v51, v51
    v_exp_f32 v52, v52
    v_exp_f32 v53, v53
    v_exp_f32 v54, v54
    v_exp_f32 v55, v55
    v_exp_f32 v56, v56
    v_exp_f32 v57, v57
    v_exp_f32 v58, v58
    v_exp_f32 v59, v59
    v_exp_f32 v60, v60
    v_exp_f32 v61, v61
    v_exp_f32 v62, v62
    v_exp_f32 v63, v63
    v_pk_add_f32 v[50:51], v[50:51], 1.0 op_sel_hi:[1,0]
    v_pk_add_f32 v[52:53], v[52:53], 1.0 op_sel_hi:[1,0]
    v_pk_add_f32 v[54:55], v[54:55], 1.0 op_sel_hi:[1,0]
    v_pk_add_f32 v[56:57], v[56:57], 1.0 op_sel_hi:[1,0]
    v_pk_add_f32 v[58:59], v[58:59], 1.0 op_sel_hi:[1,0]
    v_pk_add_f32 v[60:61], v[60:61], 1.0 op_sel_hi:[1,0]
    v_pk_add_f32 v[62:63], v[62:63], 1.0 op_sel_hi:[1,0]
    s_cmp_lg_u32 s44, 0
    s_cbranch_scc1 L_init_ok
    s_waitcnt vmcnt(0)
    s_mov_b32 s75, 0
L_init_chk:
    v_readfirstlane_b32 s48, v11
    s_cmp_ge_u32 s48, 16
    s_cbranch_scc1 L_init_ok
    s_add_u32 s75, s75, 1
    s_cmp_ge_u32 s75, 100000
    s_cbranch_scc1 L_init_ok
    s_sleep 4
    buffer_load_dword v11, off, s[36:39], 0 sc1
    s_waitcnt vmcnt(0)
    s_branch L_init_chk
L_init_ok:
    v_rcp_f32 v50, v50
    v_rcp_f32 v51, v51
    v_rcp_f32 v52, v52
    v_rcp_f32 v53, v53
    v_rcp_f32 v54, v54
    v_rcp_f32 v55, v55
    v_rcp_f32 v56, v56
    v_rcp_f32 v57, v57
    v_rcp_f32 v58, v58
    v_rcp_f32 v59, v59
    v_rcp_f32 v60, v60
    v_rcp_f32 v61, v61
    v_rcp_f32 v62, v62
    v_rcp_f32 v63, v63
    v_pk_mul_f32 v[34:35], v[34:35], v[50:51]
    v_pk_mul_f32 v[36:37], v[36:37], v[52:53]
    v_pk_mul_f32 v[38:39], v[38:39], v[54:55]
    v_pk_mul_f32 v[40:41], v[40:41], v[56:57]
    v_pk_mul_f32 v[42:43], v[42:43], v[58:59]
    v_pk_mul_f32 v[44:45], v[44:45], v[60:61]
    v_pk_mul_f32 v[46:47], v[46:47], v[62:63]
    v_pk_fma_f32 v[50:51], v[34:35], v[34:35], 0
    v_pk_fma_f32 v[16:17], v[36:37], v[36:37], v[16:17]
    v_pk_fma_f32 v[50:51], v[38:39], v[38:39], v[50:51]
    v_pk_fma_f32 v[16:17], v[40:41], v[40:41], v[16:17]
    v_pk_fma_f32 v[50:51], v[42:43], v[42:43], v[50:51]
    v_pk_fma_f32 v[16:17], v[44:45], v[44:45], v[16:17]
    v_pk_fma_f32 v[50:51], v[46:47], v[46:47], v[50:51]
    v_pk_add_f32 v[16:17], v[16:17], v[50:51]
    v_add_f32 v12, v12, v13
    v_add_f32 v14, v14, v15
    v_add_f32 v16, v16, v17
    v_mov_b32 v13, v16
    s_lshl_b32 s48, s44, 8
    s_add_u32 s49, s48, 15360
    v_permlane32_swap_b32 v12, v14
    v_permlane32_swap_b32 v13, v16
    v_add_f32 v12, v12, v14
    v_add_f32 v13, v13, v16
    ds_write_b32 v7, v12
    ds_write_b32 v7, v13 offset:8
    v_add_u32 v16, s49, v3
    v_add_u32 v17, 144384, v16
    s_lshl_b32 s49, s67, 11
    s_add_u32 s49, s49, s48
    v_subrev_u32 v6, 49152, v6
    s_mov_b32 s50, 0x88888888
    s_mov_b32 s51, 0x88888888
    s_waitcnt lgkmcnt(0)
    s_barrier
    ds_read_b32 v16, v16
    ds_read_b32 v17, v17
    v_lshrrev_b32 v14, 6, v2
    v_bfe_u32 v12, v2, 4, 2
    v_bfe_u32 v15, v2, 8, 1
    v_lshlrev_b32 v15, 1, v15
    v_xor_b32 v12, v12, v15
    v_lshlrev_b32 v12, 3, v12
    v_lshl_add_u32 v12, v14, 5, v12
    s_waitcnt lgkmcnt(0)
    v_add_f32 v16, v16, v17
    v_cndmask_b32 v16, v16, 1.0, s[50:51]
    buffer_atomic_add_f32 v16, v3, s[40:43], s49 offen
    v_cvt_pk_bf16_f32 v72, v34, v35
    v_cvt_pk_bf16_f32 v73, v36, v37
    v_cvt_pk_bf16_f32 v74, v38, v39
    v_cvt_pk_bf16_f32 v75, v40, v41
    v_cvt_pk_bf16_f32 v85, v42, v43
    v_cvt_pk_bf16_f32 v86, v44, v45
    v_cvt_pk_bf16_f32 v87, v46, v47
    s_mov_b32 s64, 0xffff0000
    s_waitcnt vmcnt(1)
    ds_write_b128 v6, v[64:67] offset:24576
    v_lshlrev_b32 v16, 16, v124
    v_and_b32 v124, s64, v124
    v_lshlrev_b32 v17, 16, v125
    v_and_b32 v125, s64, v125
    v_lshlrev_b32 v18, 16, v126
    v_and_b32 v126, s64, v126
    v_lshlrev_b32 v19, 16, v127
    v_and_b32 v127, s64, v127
    v_lshlrev_b32 v20, 16, v128
    v_and_b32 v128, s64, v128
    v_lshlrev_b32 v21, 16, v129
    v_and_b32 v129, s64, v129
    ds_write_b128 v6, v[68:71] offset:25600
    v_lshlrev_b32 v22, 16, v130
    v_and_b32 v130, s64, v130
    v_lshlrev_b32 v23, 16, v131
    v_and_b32 v131, s64, v131
    v_lshlrev_b32 v24, 16, v132
    v_and_b32 v132, s64, v132
    v_lshlrev_b32 v25, 16, v133
    v_and_b32 v133, s64, v133
    v_lshlrev_b32 v26, 16, v134
    v_and_b32 v134, s64, v134
    v_lshlrev_b32 v27, 16, v135
    v_and_b32 v135, s64, v135
    ds_write_b128 v6, v[72:75] offset:26624
    v_lshlrev_b32 v28, 16, v136
    v_and_b32 v136, s64, v136
    v_lshlrev_b32 v29, 16, v137
    v_and_b32 v137, s64, v137
    v_lshlrev_b32 v30, 16, v138
    v_and_b32 v138, s64, v138
    v_lshlrev_b32 v31, 16, v139
    v_and_b32 v139, s64, v139
    v_lshlrev_b32 v32, 16, v140
    v_and_b32 v140, s64, v140
    v_lshlrev_b32 v33, 16, v141
    v_and_b32 v141, s64, v141
    ds_write_b128 v6, v[76:79] offset:36864
    v_lshlrev_b32 v34, 16, v142
    v_and_b32 v142, s64, v142
    v_lshlrev_b32 v35, 16, v143
    v_and_b32 v143, s64, v143
    v_lshlrev_b32 v36, 16, v144
    v_and_b32 v144, s64, v144
    v_lshlrev_b32 v37, 16, v145
    v_and_b32 v145, s64, v145
    v_lshlrev_b32 v38, 16, v146
    v_and_b32 v146, s64, v146
    v_lshlrev_b32 v39, 16, v147
    v_and_b32 v147, s64, v147
    ds_write_b128 v6, v[80:83] offset:37888
    v_lshlrev_b32 v40, 16, v148
    v_and_b32 v148, s64, v148
    v_lshlrev_b32 v41, 16, v149
    v_and_b32 v149, s64, v149
    v_lshlrev_b32 v42, 16, v150
    v_and_b32 v150, s64, v150
    v_lshlrev_b32 v43, 16, v151
    v_and_b32 v151, s64, v151
    v_lshlrev_b32 v44, 16, v152
    v_and_b32 v152, s64, v152
    v_lshlrev_b32 v45, 16, v153
    v_and_b32 v153, s64, v153
    ds_write_b128 v6, v[84:87] offset:38912
    v_lshlrev_b32 v46, 16, v154
    v_and_b32 v154, s64, v154
    v_lshlrev_b32 v47, 16, v155
    v_and_b32 v155, s64, v155
    s_cmp_lt_u32 s2, 16
    s_cselect_b32 s58, s44, 0
    s_cmp_lg_u32 s58, 3
    s_cbranch_scc1 L_nored0
    v_and_b32 v109, 0x70, v2
    v_lshrrev_b32 v108, 7, v2
    v_lshl_add_u32 v108, v108, 11, v109
    s_lshl_b32 s52, s2, 7
    s_add_u32 s53, s52, 16384
    buffer_load_dwordx4 v[100:103], v108, s[40:43], s52 offen sc1
    buffer_load_dwordx4 v[104:107], v108, s[40:43], s53 offen sc1
L_nored0:
    v_lshlrev_b32 v48, 16, v156
    v_and_b32 v156, s64, v156
    v_lshlrev_b32 v49, 16, v157
    v_and_b32 v157, s64, v157
    v_lshlrev_b32 v50, 16, v158
    v_and_b32 v158, s64, v158
    v_lshlrev_b32 v51, 16, v159
    v_and_b32 v159, s64, v159
    v_lshrrev_b32 v6, 8, v2
    s_waitcnt lgkmcnt(0)
    s_barrier
    s_cmp_lg_u32 s58, 3
    s_cbranch_scc1 L_nored
    s_setprio 3
    v_and_b32 v109, 0x70, v2
    v_lshrrev_b32 v108, 7, v2
    v_lshl_add_u32 v108, v108, 11, v109
    s_add_u32 s54, s52, 131072
    s_mov_b32 s55, 1098907648
    s_mov_b32 s56, 1083289508
    s_mov_b32 s75, 0
L_red:
    s_waitcnt vmcnt(0)
    v_min_f32 v110, v103, v107
    v_cmp_gt_f32 vcc, s55, v110
    s_cbranch_vccz L_red_ok
    s_add_u32 s75, s75, 1
    s_cmp_ge_u32 s75, 100000
    s_cbranch_scc1 L_red_ok
    s_sleep 1
    buffer_load_dwordx4 v[100:103], v108, s[40:43], s52 offen sc1
    buffer_load_dwordx4 v[104:107], v108, s[40:43], s53 offen sc1
    s_branch L_red
L_red_ok:
    v_pk_add_f32 v[100:101], v[100:101], v[104:105]
    v_add_f32 v102, v102, v106
    v_mov_b32 v103, 897988541
    v_add_f32_dpp v100, v100, v100 row_ror:8
    v_add_f32_dpp v101, v101, v101 row_ror:8
    v_add_f32_dpp v102, v102, v102 row_ror:8
    v_mov_b32 v104, v100
    v_mov_b32 v105, v101
    v_mov_b32 v106, v102
    v_permlane16_swap_b32 v104, v100
    v_permlane16_swap_b32 v105, v101
    v_permlane16_swap_b32 v106, v102
    v_add_f32 v100, v100, v104
    v_add_f32 v101, v101, v105
    v_add_f32 v102, v102, v106
    v_mov_b32 v104, v100
    v_mov_b32 v105, v101
    v_mov_b32 v106, v102
    v_permlane32_swap_b32 v104, v100
    v_permlane32_swap_b32 v105, v101
    v_permlane32_swap_b32 v106, v102
    v_add_f32 v100, v100, v104
    v_add_f32 v101, v101, v105
    v_add_f32 v102, v102, v106
    v_fma_f32 v100, v100, s56, v103
    v_fma_f32 v101, v101, s56, v103
    v_fma_f32 v102, v102, s56, v103
    v_sqrt_f32 v100, v100
    v_sqrt_f32 v101, v101
    v_sqrt_f32 v102, v102
    v_mov_b32 v103, 1.0
    buffer_store_dwordx4 v[100:103], v108, s[40:43], s54 offen sc1
    s_setprio 0
    s_nop 0
L_nored:
    v_add_u32 v4, s73, v12
    ds_read_b64_tr_b16 a[0:1], v4 offset:0
    ds_read_b64_tr_b16 a[2:3], v4 offset:512
    ds_read_b64_tr_b16 a[4:5], v4 offset:3072
    ds_read_b64_tr_b16 a[6:7], v4 offset:3584
    ds_read_b64_tr_b16 a[8:9], v4 offset:6144
    ds_read_b64_tr_b16 a[10:11], v4 offset:6656
    ds_read_b64_tr_b16 a[12:13], v4 offset:9216
    ds_read_b64_tr_b16 a[14:15], v4 offset:9728
    ds_read_b64_tr_b16 a[16:17], v4 offset:1024
    ds_read_b64_tr_b16 a[18:19], v4 offset:1536
    ds_read_b64_tr_b16 a[20:21], v4 offset:4096
    ds_read_b64_tr_b16 a[22:23], v4 offset:4608
    ds_read_b64_tr_b16 a[24:25], v4 offset:7168
    ds_read_b64_tr_b16 a[26:27], v4 offset:7680
    ds_read_b64_tr_b16 a[28:29], v4 offset:10240
    ds_read_b64_tr_b16 a[30:31], v4 offset:10752
    ds_read_b64_tr_b16 a[32:33], v4 offset:2048
    ds_read_b64_tr_b16 a[34:35], v4 offset:2560
    ds_read_b64_tr_b16 a[36:37], v4 offset:5120
    ds_read_b64_tr_b16 a[38:39], v4 offset:5632
    ds_read_b64_tr_b16 a[40:41], v4 offset:8192
    ds_read_b64_tr_b16 a[42:43], v4 offset:8704
    ds_read_b64_tr_b16 a[44:45], v4 offset:11264
    ds_read_b64_tr_b16 a[46:47], v4 offset:11776
    v_add_u32 v4, s74, v12
    ds_read_b64_tr_b16 a[48:49], v4 offset:0
    ds_read_b64_tr_b16 a[50:51], v4 offset:512
    ds_read_b64_tr_b16 a[52:53], v4 offset:3072
    ds_read_b64_tr_b16 a[54:55], v4 offset:3584
    ds_read_b64_tr_b16 a[56:57], v4 offset:6144
    ds_read_b64_tr_b16 a[58:59], v4 offset:6656
    ds_read_b64_tr_b16 a[60:61], v4 offset:9216
    ds_read_b64_tr_b16 a[62:63], v4 offset:9728
    ds_read_b64_tr_b16 a[64:65], v4 offset:1024
    ds_read_b64_tr_b16 a[66:67], v4 offset:1536
    ds_read_b64_tr_b16 a[68:69], v4 offset:4096
    ds_read_b64_tr_b16 a[70:71], v4 offset:4608
    ds_read_b64_tr_b16 a[72:73], v4 offset:7168
    ds_read_b64_tr_b16 a[74:75], v4 offset:7680
    ds_read_b64_tr_b16 a[76:77], v4 offset:10240
    ds_read_b64_tr_b16 a[78:79], v4 offset:10752
    ds_read_b64_tr_b16 a[80:81], v4 offset:2048
    ds_read_b64_tr_b16 a[82:83], v4 offset:2560
    ds_read_b64_tr_b16 a[84:85], v4 offset:5120
    ds_read_b64_tr_b16 a[86:87], v4 offset:5632
    ds_read_b64_tr_b16 a[88:89], v4 offset:8192
    ds_read_b64_tr_b16 a[90:91], v4 offset:8704
    ds_read_b64_tr_b16 a[92:93], v4 offset:11264
    ds_read_b64_tr_b16 a[94:95], v4 offset:11776
    v_add_u32 v4, s62, v12
    ds_read_b64_tr_b16 v[52:53], v4 offset:0
    ds_read_b64_tr_b16 v[54:55], v4 offset:512
    ds_read_b64_tr_b16 v[56:57], v4 offset:3072
    ds_read_b64_tr_b16 v[58:59], v4 offset:3584
    ds_read_b64_tr_b16 v[60:61], v4 offset:6144
    ds_read_b64_tr_b16 v[62:63], v4 offset:6656
    ds_read_b64_tr_b16 v[64:65], v4 offset:9216
    ds_read_b64_tr_b16 v[66:67], v4 offset:9728
    ds_read_b64_tr_b16 v[68:69], v4 offset:1024
    ds_read_b64_tr_b16 v[70:71], v4 offset:1536
    ds_read_b64_tr_b16 v[72:73], v4 offset:4096
    ds_read_b64_tr_b16 v[74:75], v4 offset:4608
    ds_read_b64_tr_b16 v[76:77], v4 offset:7168
    ds_read_b64_tr_b16 v[78:79], v4 offset:7680
    ds_read_b64_tr_b16 v[80:81], v4 offset:10240
    ds_read_b64_tr_b16 v[82:83], v4 offset:10752
    ds_read_b64_tr_b16 v[84:85], v4 offset:2048
    ds_read_b64_tr_b16 v[86:87], v4 offset:2560
    ds_read_b64_tr_b16 v[88:89], v4 offset:5120
    ds_read_b64_tr_b16 v[90:91], v4 offset:5632
    ds_read_b64_tr_b16 v[92:93], v4 offset:8192
    ds_read_b64_tr_b16 v[94:95], v4 offset:8704
    ds_read_b64_tr_b16 v[96:97], v4 offset:11264
    ds_read_b64_tr_b16 v[98:99], v4 offset:11776
    v_add_u32 v7, 49152, v2
    s_waitcnt lgkmcnt(0)
    s_barrier
    v_lshrrev_b32 v15, 1, v2
    ds_read_b64 v[100:101], v15 offset:18432
    ds_read_b64 v[102:103], v15 offset:18816
    ds_read_b64 v[104:105], v15 offset:19200
    ds_read_b64 v[106:107], v15 offset:19584
    v_lshlrev_b32 v13, 4, v6
    v_add_u32 v13, 163392, v13
    v_add_u32 v15, 163392, v15
    s_waitcnt lgkmcnt(2)
    v_pk_add_f32 v[100:101], v[100:101], v[102:103]
    s_waitcnt lgkmcnt(0)
    v_pk_add_f32 v[104:105], v[104:105], v[106:107]
    v_pk_add_f32 v[100:101], v[100:101], v[104:105]
    ds_write_b64 v15, v[100:101]
    ds_read_b128 v[100:103], v13 offset:0
    ds_read_b128 v[104:107], v13 offset:64
    ds_read_b128 v[108:111], v13 offset:128
    ds_read_b128 v[112:115], v13 offset:192
    ds_read_b128 v[116:119], v13 offset:256
    ds_read_b128 v[120:123], v13 offset:320
    s_waitcnt lgkmcnt(0)
    s_barrier
    v_pk_add_f32 v[16:17], v[16:17], v[100:101]
    v_pk_add_f32 v[18:19], v[18:19], v[102:103]
    v_pk_add_f32 v[28:29], v[28:29], v[100:101]
    v_pk_add_f32 v[30:31], v[30:31], v[102:103]
    v_pk_add_f32 v[40:41], v[40:41], v[100:101]
    v_pk_add_f32 v[42:43], v[42:43], v[102:103]
    v_pk_add_f32 v[124:125], v[124:125], v[104:105]
    v_pk_add_f32 v[126:127], v[126:127], v[106:107]
    v_pk_add_f32 v[136:137], v[136:137], v[104:105]
    v_pk_add_f32 v[138:139], v[138:139], v[106:107]
    v_pk_add_f32 v[148:149], v[148:149], v[104:105]
    v_pk_add_f32 v[150:151], v[150:151], v[106:107]
    v_pk_add_f32 v[20:21], v[20:21], v[108:109]
    v_pk_add_f32 v[22:23], v[22:23], v[110:111]
    v_pk_add_f32 v[32:33], v[32:33], v[108:109]
    v_pk_add_f32 v[34:35], v[34:35], v[110:111]
    v_pk_add_f32 v[44:45], v[44:45], v[108:109]
    v_pk_add_f32 v[46:47], v[46:47], v[110:111]
    v_pk_add_f32 v[128:129], v[128:129], v[112:113]
    v_pk_add_f32 v[130:131], v[130:131], v[114:115]
    v_pk_add_f32 v[140:141], v[140:141], v[112:113]
    v_pk_add_f32 v[142:143], v[142:143], v[114:115]
    v_pk_add_f32 v[152:153], v[152:153], v[112:113]
    v_pk_add_f32 v[154:155], v[154:155], v[114:115]
    v_pk_add_f32 v[24:25], v[24:25], v[116:117]
    v_pk_add_f32 v[26:27], v[26:27], v[118:119]
    v_pk_add_f32 v[36:37], v[36:37], v[116:117]
    v_pk_add_f32 v[38:39], v[38:39], v[118:119]
    v_pk_add_f32 v[48:49], v[48:49], v[116:117]
    v_pk_add_f32 v[50:51], v[50:51], v[118:119]
    v_pk_add_f32 v[132:133], v[132:133], v[120:121]
    v_pk_add_f32 v[134:135], v[134:135], v[122:123]
    v_pk_add_f32 v[144:145], v[144:145], v[120:121]
    v_pk_add_f32 v[146:147], v[146:147], v[122:123]
    v_pk_add_f32 v[156:157], v[156:157], v[120:121]
    v_pk_add_f32 v[158:159], v[158:159], v[122:123]
    s_setprio 1
    s_barrier
    ds_read_b128 v[100:103], v2 offset:0
    ds_read_b128 v[104:107], v2 offset:12288
    ds_read_b128 v[108:111], v2 offset:1024
    ds_read_b128 v[112:115], v2 offset:13312
    s_waitcnt lgkmcnt(3)
    v_mfma_f32_16x16x32_bf16 v[16:19], v[100:103], a[0:3], v[16:19]
    ds_read_b128 v[116:119], v2 offset:2048
    ds_read_b128 v[120:123], v2 offset:14336
    v_mfma_f32_16x16x32_bf16 v[28:31], v[100:103], a[48:51], v[28:31]
    v_mfma_f32_16x16x32_bf16 v[40:43], v[100:103], v[52:55], v[40:43]
    s_waitcnt lgkmcnt(4)
    v_mfma_f32_16x16x32_bf16 v[124:127], v[104:107], a[0:3], v[124:127]
    v_mfma_f32_16x16x32_bf16 v[136:139], v[104:107], a[48:51], v[136:139]
    v_mfma_f32_16x16x32_bf16 v[148:151], v[104:107], v[52:55], v[148:151]
    s_waitcnt lgkmcnt(3)
    v_mfma_f32_16x16x32_bf16 v[16:19], v[108:111], a[4:7], v[16:19]
    ds_read_b128 v[100:103], v2 offset:3072
    ds_read_b128 v[104:107], v2 offset:15360
    v_mfma_f32_16x16x32_bf16 v[28:31], v[108:111], a[52:55], v[28:31]
    v_mfma_f32_16x16x32_bf16 v[40:43], v[108:111], v[56:59], v[40:43]
    s_waitcnt lgkmcnt(4)
    v_mfma_f32_16x16x32_bf16 v[124:127], v[112:115], a[4:7], v[124:127]
    v_mfma_f32_16x16x32_bf16 v[136:139], v[112:115], a[52:55], v[136:139]
    v_mfma_f32_16x16x32_bf16 v[148:151], v[112:115], v[56:59], v[148:151]
    s_waitcnt lgkmcnt(3)
    v_mfma_f32_16x16x32_bf16 v[16:19], v[116:119], a[8:11], v[16:19]
    ds_read_b128 v[108:111], v2 offset:4096
    ds_read_b128 v[112:115], v2 offset:16384
    v_mfma_f32_16x16x32_bf16 v[28:31], v[116:119], a[56:59], v[28:31]
    v_mfma_f32_16x16x32_bf16 v[40:43], v[116:119], v[60:63], v[40:43]
    s_waitcnt lgkmcnt(4)
    v_mfma_f32_16x16x32_bf16 v[124:127], v[120:123], a[8:11], v[124:127]
    v_mfma_f32_16x16x32_bf16 v[136:139], v[120:123], a[56:59], v[136:139]
    v_mfma_f32_16x16x32_bf16 v[148:151], v[120:123], v[60:63], v[148:151]
    s_waitcnt lgkmcnt(3)
    v_mfma_f32_16x16x32_bf16 v[16:19], v[100:103], a[12:15], v[16:19]
    ds_read_b128 v[116:119], v2 offset:5120
    ds_read_b128 v[120:123], v2 offset:17408
    v_mfma_f32_16x16x32_bf16 v[28:31], v[100:103], a[60:63], v[28:31]
    v_mfma_f32_16x16x32_bf16 v[40:43], v[100:103], v[64:67], v[40:43]
    s_waitcnt lgkmcnt(4)
    v_mfma_f32_16x16x32_bf16 v[124:127], v[104:107], a[12:15], v[124:127]
    v_mfma_f32_16x16x32_bf16 v[136:139], v[104:107], a[60:63], v[136:139]
    v_mfma_f32_16x16x32_bf16 v[148:151], v[104:107], v[64:67], v[148:151]
    s_waitcnt lgkmcnt(3)
    v_mfma_f32_16x16x32_bf16 v[16:19], v[108:111], a[16:19], v[16:19]
    ds_read_b128 v[100:103], v2 offset:6144
    ds_read_b128 v[104:107], v2 offset:18432
    v_mfma_f32_16x16x32_bf16 v[28:31], v[108:111], a[64:67], v[28:31]
    v_mfma_f32_16x16x32_bf16 v[40:43], v[108:111], v[68:71], v[40:43]
    s_waitcnt lgkmcnt(4)
    v_mfma_f32_16x16x32_bf16 v[124:127], v[112:115], a[16:19], v[124:127]
    v_mfma_f32_16x16x32_bf16 v[136:139], v[112:115], a[64:67], v[136:139]
    v_mfma_f32_16x16x32_bf16 v[148:151], v[112:115], v[68:71], v[148:151]
    s_waitcnt lgkmcnt(3)
    v_mfma_f32_16x16x32_bf16 v[16:19], v[116:119], a[20:23], v[16:19]
    ds_read_b128 v[108:111], v2 offset:7168
    ds_read_b128 v[112:115], v2 offset:19456
    v_mfma_f32_16x16x32_bf16 v[28:31], v[116:119], a[68:71], v[28:31]
    v_mfma_f32_16x16x32_bf16 v[40:43], v[116:119], v[72:75], v[40:43]
    s_waitcnt lgkmcnt(4)
    v_mfma_f32_16x16x32_bf16 v[124:127], v[120:123], a[20:23], v[124:127]
    v_mfma_f32_16x16x32_bf16 v[136:139], v[120:123], a[68:71], v[136:139]
    v_mfma_f32_16x16x32_bf16 v[148:151], v[120:123], v[72:75], v[148:151]
    s_waitcnt lgkmcnt(3)
    v_mfma_f32_16x16x32_bf16 v[16:19], v[100:103], a[24:27], v[16:19]
    ds_read_b128 v[116:119], v2 offset:8192
    ds_read_b128 v[120:123], v2 offset:20480
    v_mfma_f32_16x16x32_bf16 v[28:31], v[100:103], a[72:75], v[28:31]
    v_mfma_f32_16x16x32_bf16 v[40:43], v[100:103], v[76:79], v[40:43]
    s_waitcnt lgkmcnt(4)
    v_mfma_f32_16x16x32_bf16 v[124:127], v[104:107], a[24:27], v[124:127]
    v_mfma_f32_16x16x32_bf16 v[136:139], v[104:107], a[72:75], v[136:139]
    v_mfma_f32_16x16x32_bf16 v[148:151], v[104:107], v[76:79], v[148:151]
    s_waitcnt lgkmcnt(3)
    v_mfma_f32_16x16x32_bf16 v[16:19], v[108:111], a[28:31], v[16:19]
    ds_read_b128 v[100:103], v2 offset:9216
    ds_read_b128 v[104:107], v2 offset:21504
    v_mfma_f32_16x16x32_bf16 v[28:31], v[108:111], a[76:79], v[28:31]
    v_mfma_f32_16x16x32_bf16 v[40:43], v[108:111], v[80:83], v[40:43]
    s_waitcnt lgkmcnt(4)
    v_mfma_f32_16x16x32_bf16 v[124:127], v[112:115], a[28:31], v[124:127]
    v_mfma_f32_16x16x32_bf16 v[136:139], v[112:115], a[76:79], v[136:139]
    v_mfma_f32_16x16x32_bf16 v[148:151], v[112:115], v[80:83], v[148:151]
    s_waitcnt lgkmcnt(3)
    v_mfma_f32_16x16x32_bf16 v[16:19], v[116:119], a[32:35], v[16:19]
    ds_read_b128 v[108:111], v2 offset:10240
    ds_read_b128 v[112:115], v2 offset:22528
    v_mfma_f32_16x16x32_bf16 v[28:31], v[116:119], a[80:83], v[28:31]
    v_mfma_f32_16x16x32_bf16 v[40:43], v[116:119], v[84:87], v[40:43]
    s_waitcnt lgkmcnt(4)
    v_mfma_f32_16x16x32_bf16 v[124:127], v[120:123], a[32:35], v[124:127]
    v_mfma_f32_16x16x32_bf16 v[136:139], v[120:123], a[80:83], v[136:139]
    v_mfma_f32_16x16x32_bf16 v[148:151], v[120:123], v[84:87], v[148:151]
    s_waitcnt lgkmcnt(3)
    v_mfma_f32_16x16x32_bf16 v[16:19], v[100:103], a[36:39], v[16:19]
    ds_read_b128 v[116:119], v2 offset:11264
    ds_read_b128 v[120:123], v2 offset:23552
    v_mfma_f32_16x16x32_bf16 v[28:31], v[100:103], a[84:87], v[28:31]
    v_mfma_f32_16x16x32_bf16 v[40:43], v[100:103], v[88:91], v[40:43]
    s_waitcnt lgkmcnt(4)
    v_mfma_f32_16x16x32_bf16 v[124:127], v[104:107], a[36:39], v[124:127]
    v_mfma_f32_16x16x32_bf16 v[136:139], v[104:107], a[84:87], v[136:139]
    v_mfma_f32_16x16x32_bf16 v[148:151], v[104:107], v[88:91], v[148:151]
    s_barrier
    s_waitcnt lgkmcnt(3)
    v_mfma_f32_16x16x32_bf16 v[16:19], v[108:111], a[40:43], v[16:19]
    ds_read_b128 v[100:103], v2 offset:24576
    ds_read_b128 v[104:107], v2 offset:36864
    v_mfma_f32_16x16x32_bf16 v[28:31], v[108:111], a[88:91], v[28:31]
    v_mfma_f32_16x16x32_bf16 v[40:43], v[108:111], v[92:95], v[40:43]
    s_waitcnt lgkmcnt(4)
    v_mfma_f32_16x16x32_bf16 v[124:127], v[112:115], a[40:43], v[124:127]
    v_mfma_f32_16x16x32_bf16 v[136:139], v[112:115], a[88:91], v[136:139]
    v_mfma_f32_16x16x32_bf16 v[148:151], v[112:115], v[92:95], v[148:151]
    s_waitcnt lgkmcnt(3)
    v_mfma_f32_16x16x32_bf16 v[16:19], v[116:119], a[44:47], v[16:19]
    ds_read_b128 v[108:111], v2 offset:25600
    ds_read_b128 v[112:115], v2 offset:37888
    v_mfma_f32_16x16x32_bf16 v[28:31], v[116:119], a[92:95], v[28:31]
    v_mfma_f32_16x16x32_bf16 v[40:43], v[116:119], v[96:99], v[40:43]
    s_waitcnt lgkmcnt(4)
    v_mfma_f32_16x16x32_bf16 v[124:127], v[120:123], a[44:47], v[124:127]
    v_mfma_f32_16x16x32_bf16 v[136:139], v[120:123], a[92:95], v[136:139]
    v_mfma_f32_16x16x32_bf16 v[148:151], v[120:123], v[96:99], v[148:151]
    s_waitcnt lgkmcnt(3)
    v_mfma_f32_16x16x32_bf16 v[20:23], v[100:103], a[0:3], v[20:23]
    ds_read_b128 v[116:119], v2 offset:26624
    ds_read_b128 v[120:123], v2 offset:38912
    v_mfma_f32_16x16x32_bf16 v[32:35], v[100:103], a[48:51], v[32:35]
    v_mfma_f32_16x16x32_bf16 v[44:47], v[100:103], v[52:55], v[44:47]
    s_waitcnt lgkmcnt(4)
    v_mfma_f32_16x16x32_bf16 v[128:131], v[104:107], a[0:3], v[128:131]
    v_mfma_f32_16x16x32_bf16 v[140:143], v[104:107], a[48:51], v[140:143]
    v_mfma_f32_16x16x32_bf16 v[152:155], v[104:107], v[52:55], v[152:155]
    s_waitcnt lgkmcnt(3)
    v_mfma_f32_16x16x32_bf16 v[20:23], v[108:111], a[4:7], v[20:23]
    ds_read_b128 v[100:103], v2 offset:27648
    ds_read_b128 v[104:107], v2 offset:39936
    v_mfma_f32_16x16x32_bf16 v[32:35], v[108:111], a[52:55], v[32:35]
    v_mfma_f32_16x16x32_bf16 v[44:47], v[108:111], v[56:59], v[44:47]
    s_waitcnt lgkmcnt(4)
    v_mfma_f32_16x16x32_bf16 v[128:131], v[112:115], a[4:7], v[128:131]
    v_mfma_f32_16x16x32_bf16 v[140:143], v[112:115], a[52:55], v[140:143]
    v_mfma_f32_16x16x32_bf16 v[152:155], v[112:115], v[56:59], v[152:155]
    s_waitcnt lgkmcnt(3)
    v_mfma_f32_16x16x32_bf16 v[20:23], v[116:119], a[8:11], v[20:23]
    ds_read_b128 v[108:111], v2 offset:28672
    ds_read_b128 v[112:115], v2 offset:40960
    v_mfma_f32_16x16x32_bf16 v[32:35], v[116:119], a[56:59], v[32:35]
    v_mfma_f32_16x16x32_bf16 v[44:47], v[116:119], v[60:63], v[44:47]
    s_waitcnt lgkmcnt(4)
    v_mfma_f32_16x16x32_bf16 v[128:131], v[120:123], a[8:11], v[128:131]
    v_mfma_f32_16x16x32_bf16 v[140:143], v[120:123], a[56:59], v[140:143]
    v_mfma_f32_16x16x32_bf16 v[152:155], v[120:123], v[60:63], v[152:155]
    s_waitcnt lgkmcnt(3)
    v_mfma_f32_16x16x32_bf16 v[20:23], v[100:103], a[12:15], v[20:23]
    ds_read_b128 v[116:119], v2 offset:29696
    ds_read_b128 v[120:123], v2 offset:41984
    v_mfma_f32_16x16x32_bf16 v[32:35], v[100:103], a[60:63], v[32:35]
    v_mfma_f32_16x16x32_bf16 v[44:47], v[100:103], v[64:67], v[44:47]
    s_waitcnt lgkmcnt(4)
    v_mfma_f32_16x16x32_bf16 v[128:131], v[104:107], a[12:15], v[128:131]
    v_mfma_f32_16x16x32_bf16 v[140:143], v[104:107], a[60:63], v[140:143]
    v_mfma_f32_16x16x32_bf16 v[152:155], v[104:107], v[64:67], v[152:155]
    s_waitcnt lgkmcnt(3)
    v_mfma_f32_16x16x32_bf16 v[20:23], v[108:111], a[16:19], v[20:23]
    ds_read_b128 v[100:103], v2 offset:30720
    ds_read_b128 v[104:107], v2 offset:43008
    v_mfma_f32_16x16x32_bf16 v[32:35], v[108:111], a[64:67], v[32:35]
    v_mfma_f32_16x16x32_bf16 v[44:47], v[108:111], v[68:71], v[44:47]
    s_waitcnt lgkmcnt(4)
    v_mfma_f32_16x16x32_bf16 v[128:131], v[112:115], a[16:19], v[128:131]
    v_mfma_f32_16x16x32_bf16 v[140:143], v[112:115], a[64:67], v[140:143]
    v_mfma_f32_16x16x32_bf16 v[152:155], v[112:115], v[68:71], v[152:155]
    s_waitcnt lgkmcnt(3)
    v_mfma_f32_16x16x32_bf16 v[20:23], v[116:119], a[20:23], v[20:23]
    ds_read_b128 v[108:111], v2 offset:31744
    ds_read_b128 v[112:115], v2 offset:44032
    v_mfma_f32_16x16x32_bf16 v[32:35], v[116:119], a[68:71], v[32:35]
    v_mfma_f32_16x16x32_bf16 v[44:47], v[116:119], v[72:75], v[44:47]
    s_waitcnt lgkmcnt(4)
    v_mfma_f32_16x16x32_bf16 v[128:131], v[120:123], a[20:23], v[128:131]
    v_mfma_f32_16x16x32_bf16 v[140:143], v[120:123], a[68:71], v[140:143]
    v_mfma_f32_16x16x32_bf16 v[152:155], v[120:123], v[72:75], v[152:155]
    s_waitcnt lgkmcnt(3)
    v_mfma_f32_16x16x32_bf16 v[20:23], v[100:103], a[24:27], v[20:23]
    ds_read_b128 v[116:119], v2 offset:32768
    ds_read_b128 v[120:123], v2 offset:45056
    v_mfma_f32_16x16x32_bf16 v[32:35], v[100:103], a[72:75], v[32:35]
    v_mfma_f32_16x16x32_bf16 v[44:47], v[100:103], v[76:79], v[44:47]
    s_waitcnt lgkmcnt(4)
    v_mfma_f32_16x16x32_bf16 v[128:131], v[104:107], a[24:27], v[128:131]
    v_mfma_f32_16x16x32_bf16 v[140:143], v[104:107], a[72:75], v[140:143]
    v_mfma_f32_16x16x32_bf16 v[152:155], v[104:107], v[76:79], v[152:155]
    s_waitcnt lgkmcnt(3)
    v_mfma_f32_16x16x32_bf16 v[20:23], v[108:111], a[28:31], v[20:23]
    ds_read_b128 v[100:103], v2 offset:33792
    ds_read_b128 v[104:107], v2 offset:46080
    v_mfma_f32_16x16x32_bf16 v[32:35], v[108:111], a[76:79], v[32:35]
    v_mfma_f32_16x16x32_bf16 v[44:47], v[108:111], v[80:83], v[44:47]
    s_waitcnt lgkmcnt(4)
    v_mfma_f32_16x16x32_bf16 v[128:131], v[112:115], a[28:31], v[128:131]
    v_mfma_f32_16x16x32_bf16 v[140:143], v[112:115], a[76:79], v[140:143]
    v_mfma_f32_16x16x32_bf16 v[152:155], v[112:115], v[80:83], v[152:155]
    s_waitcnt lgkmcnt(3)
    v_mfma_f32_16x16x32_bf16 v[20:23], v[116:119], a[32:35], v[20:23]
    ds_read_b128 v[108:111], v2 offset:34816
    ds_read_b128 v[112:115], v2 offset:47104
    v_mfma_f32_16x16x32_bf16 v[32:35], v[116:119], a[80:83], v[32:35]
    v_mfma_f32_16x16x32_bf16 v[44:47], v[116:119], v[84:87], v[44:47]
    s_waitcnt lgkmcnt(4)
    v_mfma_f32_16x16x32_bf16 v[128:131], v[120:123], a[32:35], v[128:131]
    v_mfma_f32_16x16x32_bf16 v[140:143], v[120:123], a[80:83], v[140:143]
    v_mfma_f32_16x16x32_bf16 v[152:155], v[120:123], v[84:87], v[152:155]
    s_waitcnt lgkmcnt(3)
    v_mfma_f32_16x16x32_bf16 v[20:23], v[100:103], a[36:39], v[20:23]
    ds_read_b128 v[116:119], v2 offset:35840
    ds_read_b128 v[120:123], v2 offset:48128
    v_mfma_f32_16x16x32_bf16 v[32:35], v[100:103], a[84:87], v[32:35]
    v_mfma_f32_16x16x32_bf16 v[44:47], v[100:103], v[88:91], v[44:47]
    s_waitcnt lgkmcnt(4)
    v_mfma_f32_16x16x32_bf16 v[128:131], v[104:107], a[36:39], v[128:131]
    v_mfma_f32_16x16x32_bf16 v[140:143], v[104:107], a[84:87], v[140:143]
    v_mfma_f32_16x16x32_bf16 v[152:155], v[104:107], v[88:91], v[152:155]
    s_barrier
    s_waitcnt lgkmcnt(3)
    v_mfma_f32_16x16x32_bf16 v[20:23], v[108:111], a[40:43], v[20:23]
    ds_read_b128 v[100:103], v7 offset:0
    ds_read_b128 v[104:107], v7 offset:12288
    v_mfma_f32_16x16x32_bf16 v[32:35], v[108:111], a[88:91], v[32:35]
    v_mfma_f32_16x16x32_bf16 v[44:47], v[108:111], v[92:95], v[44:47]
    s_waitcnt lgkmcnt(4)
    v_mfma_f32_16x16x32_bf16 v[128:131], v[112:115], a[40:43], v[128:131]
    v_mfma_f32_16x16x32_bf16 v[140:143], v[112:115], a[88:91], v[140:143]
    v_mfma_f32_16x16x32_bf16 v[152:155], v[112:115], v[92:95], v[152:155]
    s_waitcnt lgkmcnt(3)
    v_mfma_f32_16x16x32_bf16 v[20:23], v[116:119], a[44:47], v[20:23]
    ds_read_b128 v[108:111], v7 offset:1024
    ds_read_b128 v[112:115], v7 offset:13312
    v_mfma_f32_16x16x32_bf16 v[32:35], v[116:119], a[92:95], v[32:35]
    v_mfma_f32_16x16x32_bf16 v[44:47], v[116:119], v[96:99], v[44:47]
    s_waitcnt lgkmcnt(4)
    v_mfma_f32_16x16x32_bf16 v[128:131], v[120:123], a[44:47], v[128:131]
    v_mfma_f32_16x16x32_bf16 v[140:143], v[120:123], a[92:95], v[140:143]
    v_mfma_f32_16x16x32_bf16 v[152:155], v[120:123], v[96:99], v[152:155]
    s_waitcnt lgkmcnt(3)
    v_mfma_f32_16x16x32_bf16 v[24:27], v[100:103], a[0:3], v[24:27]
    ds_read_b128 v[116:119], v7 offset:2048
    ds_read_b128 v[120:123], v7 offset:14336
    v_mfma_f32_16x16x32_bf16 v[36:39], v[100:103], a[48:51], v[36:39]
    v_mfma_f32_16x16x32_bf16 v[48:51], v[100:103], v[52:55], v[48:51]
    s_waitcnt lgkmcnt(4)
    v_mfma_f32_16x16x32_bf16 v[132:135], v[104:107], a[0:3], v[132:135]
    v_mfma_f32_16x16x32_bf16 v[144:147], v[104:107], a[48:51], v[144:147]
    v_cvt_pk_bf16_f32 v16, v16, v124
    v_mfma_f32_16x16x32_bf16 v[156:159], v[104:107], v[52:55], v[156:159]
    v_cvt_pk_bf16_f32 v17, v17, v125
    s_waitcnt lgkmcnt(3)
    v_mfma_f32_16x16x32_bf16 v[24:27], v[108:111], a[4:7], v[24:27]
    ds_read_b128 v[100:103], v7 offset:3072
    ds_read_b128 v[104:107], v7 offset:15360
    v_mfma_f32_16x16x32_bf16 v[36:39], v[108:111], a[52:55], v[36:39]
    v_cvt_pk_bf16_f32 v18, v18, v126
    v_mfma_f32_16x16x32_bf16 v[48:51], v[108:111], v[56:59], v[48:51]
    v_cvt_pk_bf16_f32 v19, v19, v127
    s_waitcnt lgkmcnt(4)
    v_mfma_f32_16x16x32_bf16 v[132:135], v[112:115], a[4:7], v[132:135]
    buffer_store_dwordx4 v[16:19], v0, s[32:35], 0 offen offset:0 sc1 nt
    v_mfma_f32_16x16x32_bf16 v[144:147], v[112:115], a[52:55], v[144:147]
    v_cvt_pk_bf16_f32 v20, v20, v128
    v_mfma_f32_16x16x32_bf16 v[156:159], v[112:115], v[56:59], v[156:159]
    v_cvt_pk_bf16_f32 v21, v21, v129
    s_waitcnt lgkmcnt(3)
    v_mfma_f32_16x16x32_bf16 v[24:27], v[116:119], a[8:11], v[24:27]
    ds_read_b128 v[108:111], v7 offset:4096
    ds_read_b128 v[112:115], v7 offset:16384
    v_mfma_f32_16x16x32_bf16 v[36:39], v[116:119], a[56:59], v[36:39]
    v_cvt_pk_bf16_f32 v22, v22, v130
    v_mfma_f32_16x16x32_bf16 v[48:51], v[116:119], v[60:63], v[48:51]
    v_cvt_pk_bf16_f32 v23, v23, v131
    s_waitcnt lgkmcnt(4)
    v_mfma_f32_16x16x32_bf16 v[132:135], v[120:123], a[8:11], v[132:135]
    buffer_store_dwordx4 v[20:23], v0, s[32:35], 0 offen offset:64 sc1 nt
    v_mfma_f32_16x16x32_bf16 v[144:147], v[120:123], a[56:59], v[144:147]
    v_cvt_pk_bf16_f32 v28, v28, v136
    v_mfma_f32_16x16x32_bf16 v[156:159], v[120:123], v[60:63], v[156:159]
    v_cvt_pk_bf16_f32 v29, v29, v137
    s_waitcnt lgkmcnt(3)
    v_mfma_f32_16x16x32_bf16 v[24:27], v[100:103], a[12:15], v[24:27]
    ds_read_b128 v[116:119], v7 offset:5120
    ds_read_b128 v[120:123], v7 offset:17408
    v_mfma_f32_16x16x32_bf16 v[36:39], v[100:103], a[60:63], v[36:39]
    v_cvt_pk_bf16_f32 v30, v30, v138
    v_mfma_f32_16x16x32_bf16 v[48:51], v[100:103], v[64:67], v[48:51]
    v_cvt_pk_bf16_f32 v31, v31, v139
    s_waitcnt lgkmcnt(4)
    v_mfma_f32_16x16x32_bf16 v[132:135], v[104:107], a[12:15], v[132:135]
    buffer_store_dwordx4 v[28:31], v1, s[32:35], 0 offen offset:0 sc1 nt
    v_mfma_f32_16x16x32_bf16 v[144:147], v[104:107], a[60:63], v[144:147]
    v_cvt_pk_bf16_f32 v32, v32, v140
    v_mfma_f32_16x16x32_bf16 v[156:159], v[104:107], v[64:67], v[156:159]
    v_cvt_pk_bf16_f32 v33, v33, v141
    s_waitcnt lgkmcnt(3)
    v_mfma_f32_16x16x32_bf16 v[24:27], v[108:111], a[16:19], v[24:27]
    ds_read_b128 v[100:103], v7 offset:6144
    ds_read_b128 v[104:107], v7 offset:18432
    v_mfma_f32_16x16x32_bf16 v[36:39], v[108:111], a[64:67], v[36:39]
    v_cvt_pk_bf16_f32 v34, v34, v142
    v_mfma_f32_16x16x32_bf16 v[48:51], v[108:111], v[68:71], v[48:51]
    v_cvt_pk_bf16_f32 v35, v35, v143
    s_waitcnt lgkmcnt(4)
    v_mfma_f32_16x16x32_bf16 v[132:135], v[112:115], a[16:19], v[132:135]
    buffer_store_dwordx4 v[32:35], v1, s[32:35], 0 offen offset:64 sc1 nt
    v_mfma_f32_16x16x32_bf16 v[144:147], v[112:115], a[64:67], v[144:147]
    v_cvt_pk_bf16_f32 v40, v40, v148
    v_mfma_f32_16x16x32_bf16 v[156:159], v[112:115], v[68:71], v[156:159]
    v_cvt_pk_bf16_f32 v41, v41, v149
    s_waitcnt lgkmcnt(3)
    v_mfma_f32_16x16x32_bf16 v[24:27], v[116:119], a[20:23], v[24:27]
    ds_read_b128 v[108:111], v7 offset:7168
    ds_read_b128 v[112:115], v7 offset:19456
    v_mfma_f32_16x16x32_bf16 v[36:39], v[116:119], a[68:71], v[36:39]
    v_cvt_pk_bf16_f32 v42, v42, v150
    v_mfma_f32_16x16x32_bf16 v[48:51], v[116:119], v[72:75], v[48:51]
    v_cvt_pk_bf16_f32 v43, v43, v151
    s_waitcnt lgkmcnt(4)
    v_mfma_f32_16x16x32_bf16 v[132:135], v[120:123], a[20:23], v[132:135]
    buffer_store_dwordx4 v[40:43], v8, s[32:35], 0 offen offset:0 sc1 nt
    v_mfma_f32_16x16x32_bf16 v[144:147], v[120:123], a[68:71], v[144:147]
    v_cvt_pk_bf16_f32 v44, v44, v152
    v_mfma_f32_16x16x32_bf16 v[156:159], v[120:123], v[72:75], v[156:159]
    v_cvt_pk_bf16_f32 v45, v45, v153
    s_waitcnt lgkmcnt(3)
    v_mfma_f32_16x16x32_bf16 v[24:27], v[100:103], a[24:27], v[24:27]
    ds_read_b128 v[116:119], v7 offset:8192
    ds_read_b128 v[120:123], v7 offset:20480
    v_mfma_f32_16x16x32_bf16 v[36:39], v[100:103], a[72:75], v[36:39]
    v_cvt_pk_bf16_f32 v46, v46, v154
    v_mfma_f32_16x16x32_bf16 v[48:51], v[100:103], v[76:79], v[48:51]
    v_cvt_pk_bf16_f32 v47, v47, v155
    s_waitcnt lgkmcnt(4)
    v_mfma_f32_16x16x32_bf16 v[132:135], v[104:107], a[24:27], v[132:135]
    buffer_store_dwordx4 v[44:47], v8, s[32:35], 0 offen offset:64 sc1 nt
    v_mfma_f32_16x16x32_bf16 v[144:147], v[104:107], a[72:75], v[144:147]
    v_mfma_f32_16x16x32_bf16 v[156:159], v[104:107], v[76:79], v[156:159]
    s_waitcnt lgkmcnt(3)
    v_mfma_f32_16x16x32_bf16 v[24:27], v[108:111], a[28:31], v[24:27]
    ds_read_b128 v[100:103], v7 offset:9216
    ds_read_b128 v[104:107], v7 offset:21504
    v_mfma_f32_16x16x32_bf16 v[36:39], v[108:111], a[76:79], v[36:39]
    v_mfma_f32_16x16x32_bf16 v[48:51], v[108:111], v[80:83], v[48:51]
    s_waitcnt lgkmcnt(4)
    v_mfma_f32_16x16x32_bf16 v[132:135], v[112:115], a[28:31], v[132:135]
    v_mfma_f32_16x16x32_bf16 v[144:147], v[112:115], a[76:79], v[144:147]
    v_mfma_f32_16x16x32_bf16 v[156:159], v[112:115], v[80:83], v[156:159]
    s_waitcnt lgkmcnt(3)
    v_mfma_f32_16x16x32_bf16 v[24:27], v[116:119], a[32:35], v[24:27]
    ds_read_b128 v[108:111], v7 offset:10240
    ds_read_b128 v[112:115], v7 offset:22528
    v_mfma_f32_16x16x32_bf16 v[36:39], v[116:119], a[80:83], v[36:39]
    v_mfma_f32_16x16x32_bf16 v[48:51], v[116:119], v[84:87], v[48:51]
    s_waitcnt lgkmcnt(4)
    v_mfma_f32_16x16x32_bf16 v[132:135], v[120:123], a[32:35], v[132:135]
    v_mfma_f32_16x16x32_bf16 v[144:147], v[120:123], a[80:83], v[144:147]
    v_mfma_f32_16x16x32_bf16 v[156:159], v[120:123], v[84:87], v[156:159]
    s_waitcnt lgkmcnt(3)
    v_mfma_f32_16x16x32_bf16 v[24:27], v[100:103], a[36:39], v[24:27]
    ds_read_b128 v[116:119], v7 offset:11264
    ds_read_b128 v[120:123], v7 offset:23552
    v_mfma_f32_16x16x32_bf16 v[36:39], v[100:103], a[84:87], v[36:39]
    v_mfma_f32_16x16x32_bf16 v[48:51], v[100:103], v[88:91], v[48:51]
    s_waitcnt lgkmcnt(4)
    v_mfma_f32_16x16x32_bf16 v[132:135], v[104:107], a[36:39], v[132:135]
    v_mfma_f32_16x16x32_bf16 v[144:147], v[104:107], a[84:87], v[144:147]
    v_mfma_f32_16x16x32_bf16 v[156:159], v[104:107], v[88:91], v[156:159]
    s_waitcnt lgkmcnt(3)
    v_mfma_f32_16x16x32_bf16 v[24:27], v[108:111], a[40:43], v[24:27]
    v_mfma_f32_16x16x32_bf16 v[36:39], v[108:111], a[88:91], v[36:39]
    v_mfma_f32_16x16x32_bf16 v[48:51], v[108:111], v[92:95], v[48:51]
    s_waitcnt lgkmcnt(2)
    v_mfma_f32_16x16x32_bf16 v[132:135], v[112:115], a[40:43], v[132:135]
    v_mfma_f32_16x16x32_bf16 v[144:147], v[112:115], a[88:91], v[144:147]
    v_mfma_f32_16x16x32_bf16 v[156:159], v[112:115], v[92:95], v[156:159]
    s_waitcnt lgkmcnt(1)
    v_mfma_f32_16x16x32_bf16 v[24:27], v[116:119], a[44:47], v[24:27]
    s_waitcnt lgkmcnt(0)
    v_mfma_f32_16x16x32_bf16 v[132:135], v[120:123], a[44:47], v[132:135]
    v_mfma_f32_16x16x32_bf16 v[36:39], v[116:119], a[92:95], v[36:39]
    v_mfma_f32_16x16x32_bf16 v[144:147], v[120:123], a[92:95], v[144:147]
    v_mfma_f32_16x16x32_bf16 v[48:51], v[116:119], v[96:99], v[48:51]
    v_mfma_f32_16x16x32_bf16 v[156:159], v[120:123], v[96:99], v[156:159]
    s_nop 3
    v_cvt_pk_bf16_f32 v24, v24, v132
    v_cvt_pk_bf16_f32 v25, v25, v133
    v_cvt_pk_bf16_f32 v26, v26, v134
    v_cvt_pk_bf16_f32 v27, v27, v135
    buffer_store_dwordx4 v[24:27], v0, s[32:35], 0 offen offset:128 sc1 nt
    v_cvt_pk_bf16_f32 v36, v36, v144
    v_cvt_pk_bf16_f32 v37, v37, v145
    v_cvt_pk_bf16_f32 v38, v38, v146
    v_cvt_pk_bf16_f32 v39, v39, v147
    buffer_store_dwordx4 v[36:39], v1, s[32:35], 0 offen offset:128 sc1 nt
    v_cvt_pk_bf16_f32 v48, v48, v156
    v_cvt_pk_bf16_f32 v49, v49, v157
    v_cvt_pk_bf16_f32 v50, v50, v158
    v_cvt_pk_bf16_f32 v51, v51, v159
    buffer_store_dwordx4 v[48:51], v8, s[32:35], 0 offen offset:128 sc1 nt
    s_branch L_done
L_b1:
    s_waitcnt vmcnt(0) lgkmcnt(0)
    s_barrier
    v_lshrrev_b32 v14, 2, v11
    v_mul_u32_u24 v14, 768, v14
    v_and_b32 v15, 3, v11
    v_lshl_add_u32 v15, v15, 4, v14
    s_mul_i32 s48, s45, 192
    s_mul_i32 s51, s45, 18432
    s_add_u32 s50, s48, 0
    s_add_u32 m0, s51, 49152
    s_nop 0
    buffer_load_dwordx4 v15, s[16:19], s50 offen offset:0 lds
    s_add_u32 m0, s51, 55232
    s_nop 0
    buffer_load_dwordx4 v15, s[16:19], s50 offen offset:64 lds
    s_add_u32 m0, s51, 61312
    s_nop 0
    buffer_load_dwordx4 v15, s[16:19], s50 offen offset:128 lds
    s_add_u32 s50, s48, 12288
    s_add_u32 m0, s51, 50176
    s_nop 0
    buffer_load_dwordx4 v15, s[16:19], s50 offen offset:0 lds
    s_add_u32 m0, s51, 56256
    s_nop 0
    buffer_load_dwordx4 v15, s[16:19], s50 offen offset:64 lds
    s_add_u32 m0, s51, 62336
    s_nop 0
    buffer_load_dwordx4 v15, s[16:19], s50 offen offset:128 lds
    s_add_u32 s50, s48, 24576
    s_add_u32 m0, s51, 51200
    s_nop 0
    buffer_load_dwordx4 v15, s[16:19], s50 offen offset:0 lds
    s_add_u32 m0, s51, 57280
    s_nop 0
    buffer_load_dwordx4 v15, s[16:19], s50 offen offset:64 lds
    s_add_u32 m0, s51, 63360
    s_nop 0
    buffer_load_dwordx4 v15, s[16:19], s50 offen offset:128 lds
    s_add_u32 s50, s48, 36864
    s_add_u32 m0, s51, 52224
    s_nop 0
    buffer_load_dwordx4 v15, s[16:19], s50 offen offset:0 lds
    s_add_u32 m0, s51, 58304
    s_nop 0
    buffer_load_dwordx4 v15, s[16:19], s50 offen offset:64 lds
    s_add_u32 m0, s51, 64384
    s_nop 0
    buffer_load_dwordx4 v15, s[16:19], s50 offen offset:128 lds
    s_add_u32 s50, s48, 49152
    s_add_u32 m0, s51, 53248
    s_nop 0
    buffer_load_dwordx4 v15, s[16:19], s50 offen offset:0 lds
    s_add_u32 m0, s51, 59328
    s_nop 0
    buffer_load_dwordx4 v15, s[16:19], s50 offen offset:64 lds
    s_add_u32 m0, s51, 65408
    s_nop 0
    buffer_load_dwordx4 v15, s[16:19], s50 offen offset:128 lds
    s_add_u32 s50, s48, 61440
    s_add_u32 m0, s51, 54272
    s_nop 0
    buffer_load_dwordx4 v15, s[16:19], s50 offen offset:0 lds
    s_add_u32 m0, s51, 60352
    s_nop 0
    buffer_load_dwordx4 v15, s[16:19], s50 offen offset:64 lds
    s_add_u32 m0, s51, 66432
    s_nop 0
    buffer_load_dwordx4 v15, s[16:19], s50 offen offset:128 lds
    s_mov_b32 s60, 1084043516
    s_mov_b32 s61, 1084043516
    s_mov_b32 s65, 0x00003f80
    s_mov_b32 s66, 0x3f800000
    v_lshlrev_b32 v3, 2, v11
    v_and_b32 v125, 8, v11
    v_lshlrev_b32 v125, 3, v125
    v_xor_b32 v4, v125, v2
    v_lshrrev_b32 v125, 2, v120
    v_lshrrev_b32 v122, 5, v11
    v_lshl_add_u32 v125, v122, 2, v125
    v_and_b32 v124, 1, v121
    v_lshlrev_b32 v124, 5, v124
    v_lshl_add_u32 v125, v125, 6, v124
    v_and_b32 v124, 3, v11
    v_lshlrev_b32 v124, 3, v124
    s_mul_i32 s48, s45, 18432
    s_add_u32 s48, s48, 49152
    v_add3_u32 v12, v125, v124, s48
    v_and_b32 v123, 31, v11
    s_mul_i32 s48, s45, 96
    v_add_u32 v124, s48, v123
    v_bfe_u32 v125, v123, 2, 1
    v_xor_b32 v125, v125, v122
    v_lshlrev_b32 v125, 4, v125
    v_lshl_add_u32 v125, v124, 5, v125
    v_add_u32 v5, 122880, v125
    v_add_u32 v6, 49152, v125
    s_lshl_b32 s48, s45, 9
    s_add_u32 s48, s48, 15360
    v_lshlrev_b32 v123, 4, v123
    v_lshlrev_b32 v122, 2, v122
    v_add3_u32 v7, v122, v123, s48
    s_mov_b32 s64, 0xffff0000
    s_mul_i32 s69, s45, 192
    s_mul_i32 s70, s45, 18432
    s_add_u32 s71, s70, 6144
    s_add_u32 s72, s70, 12288
    v_lshl_add_u32 v125, v124, 3, v122
    v_add_u32 v8, 12288, v125
    v_mul_u32_u24 v9, 768, v121
    v_lshl_add_u32 v9, v120, 2, v9
    v_lshlrev_b32 v10, 3, v121
    v_lshlrev_b32 v121, 4, v121
    v_bfe_u32 v122, v120, 1, 1
    v_add_u32 v122, 10, v122
    v_mul_u32_u24 v122, 43008, v122
    v_and_b32 v123, 1, v120
    v_add_u32 v123, 12, v123
    v_mul_u32_u24 v123, 192, v123
    v_add3_u32 v122, v122, v123, v121
    s_lshl_b32 s48, s45, 6
    s_add_u32 s48, s48, s68
    v_add_u32 v122, s48, v122
    v_mov_b32 v123, 2130706432
    v_cmp_gt_u32 vcc, 4, v120
    s_nop 1
    v_cndmask_b32 v0, v123, v122, vcc
    v_lshrrev_b32 v122, 5, v11
    v_lshlrev_b32 v122, 6, v122
    v_add_lshl_u32 v1, v122, v11, 1
    s_waitcnt vmcnt(0)
    ds_read_b64_tr_b16 a[0:1], v12 offset:0
    ds_read_b64_tr_b16 a[2:3], v12 offset:1024
    ds_read_b64_tr_b16 a[4:5], v12 offset:512
    ds_read_b64_tr_b16 a[6:7], v12 offset:1536
    ds_read_b64_tr_b16 a[8:9], v12 offset:2048
    ds_read_b64_tr_b16 a[10:11], v12 offset:3072
    ds_read_b64_tr_b16 a[12:13], v12 offset:2560
    ds_read_b64_tr_b16 a[14:15], v12 offset:3584
    ds_read_b64_tr_b16 a[16:17], v12 offset:4096
    ds_read_b64_tr_b16 a[18:19], v12 offset:5120
    ds_read_b64_tr_b16 a[20:21], v12 offset:4608
    ds_read_b64_tr_b16 a[22:23], v12 offset:5632
    ds_read_b64_tr_b16 a[24:25], v12 offset:6144
    ds_read_b64_tr_b16 a[26:27], v12 offset:7168
    ds_read_b64_tr_b16 a[28:29], v12 offset:6656
    ds_read_b64_tr_b16 a[30:31], v12 offset:7680
    ds_read_b64_tr_b16 a[32:33], v12 offset:8192
    ds_read_b64_tr_b16 a[34:35], v12 offset:9216
    ds_read_b64_tr_b16 a[36:37], v12 offset:8704
    ds_read_b64_tr_b16 a[38:39], v12 offset:9728
    ds_read_b64_tr_b16 a[40:41], v12 offset:10240
    ds_read_b64_tr_b16 a[42:43], v12 offset:11264
    ds_read_b64_tr_b16 a[44:45], v12 offset:10752
    ds_read_b64_tr_b16 a[46:47], v12 offset:11776
    ds_read_b64_tr_b16 a[48:49], v12 offset:12288
    ds_read_b64_tr_b16 a[50:51], v12 offset:13312
    ds_read_b64_tr_b16 a[52:53], v12 offset:12800
    ds_read_b64_tr_b16 a[54:55], v12 offset:13824
    ds_read_b64_tr_b16 a[56:57], v12 offset:14336
    ds_read_b64_tr_b16 a[58:59], v12 offset:15360
    ds_read_b64_tr_b16 a[60:61], v12 offset:14848
    ds_read_b64_tr_b16 a[62:63], v12 offset:15872
    ds_read_b64_tr_b16 a[64:65], v12 offset:16384
    ds_read_b64_tr_b16 a[66:67], v12 offset:17408
    ds_read_b64_tr_b16 a[68:69], v12 offset:16896
    ds_read_b64_tr_b16 a[70:71], v12 offset:17920
    buffer_load_dwordx2 v[148:149], v10, s[28:31], s69 offen offset:0
    buffer_load_dwordx2 v[150:151], v10, s[28:31], s69 offen offset:32
    buffer_load_dwordx2 v[152:153], v10, s[28:31], s69 offen offset:64
    buffer_load_dwordx2 v[154:155], v10, s[28:31], s69 offen offset:96
    buffer_load_dwordx2 v[156:157], v10, s[28:31], s69 offen offset:128
    buffer_load_dwordx2 v[158:159], v10, s[28:31], s69 offen offset:160
    buffer_load_dword v100, v9, s[20:23], s70 offen offset:0
    buffer_load_dword v101, v9, s[20:23], s70 offen offset:192
    buffer_load_dword v102, v9, s[20:23], s70 offen offset:384
    buffer_load_dword v103, v9, s[20:23], s70 offen offset:576
    buffer_load_dword v104, v9, s[20:23], s70 offen offset:3072
    buffer_load_dword v105, v9, s[20:23], s70 offen offset:3264
    buffer_load_dword v106, v9, s[20:23], s70 offen offset:3456
    buffer_load_dword v107, v9, s[20:23], s70 offen offset:3648
    buffer_load_dword v108, v9, s[20:23], s71 offen offset:0
    buffer_load_dword v109, v9, s[20:23], s71 offen offset:192
    buffer_load_dword v110, v9, s[20:23], s71 offen offset:384
    buffer_load_dword v111, v9, s[20:23], s71 offen offset:576
    buffer_load_dword v112, v9, s[20:23], s71 offen offset:3072
    buffer_load_dword v113, v9, s[20:23], s71 offen offset:3264
    buffer_load_dword v114, v9, s[20:23], s71 offen offset:3456
    buffer_load_dword v115, v9, s[20:23], s71 offen offset:3648
    buffer_load_dword v116, v9, s[20:23], s72 offen offset:0
    buffer_load_dword v117, v9, s[20:23], s72 offen offset:192
    s_cmp_lg_u32 s44, 7
    s_cbranch_scc1 L_not7
    s_lshr_b32 s57, s2, 3
    s_mul_i32 s57, s57, 2304
    v_lshlrev_b32 v15, 3, v2
    v_add_u32 v16, s57, v15
    v_mov_b32 v17, 2130706432
    v_cmp_gt_u32 vcc, 288, v2
    s_nop 1
    v_cndmask_b32 v16, v17, v16, vcc
    buffer_load_dword v99, v16, s[20:23], 0 offen
    buffer_load_dword v99, v15, s[24:27], 0 offen
    buffer_load_dword v99, v15, s[28:31], 0 offen
    s_cmp_ge_u32 s2, 16
    s_cbranch_scc1 L_nozero
    v_mov_b64 v[84:85], 0
    v_mov_b64 v[86:87], 0
    s_mul_i32 s48, s2, 2048
    s_lshl_b32 s50, s2, 7
    s_add_u32 s50, s50, 131072
    buffer_store_dwordx4 v[84:87], v2, s[40:43], s48 offen offset:0 sc1
    buffer_store_dwordx4 v[84:87], v2, s[40:43], s48 offen offset:1024 sc1
    v_and_b32 v83, 0x70, v2
    v_lshrrev_b32 v82, 7, v2
    v_lshl_add_u32 v82, v82, 11, v83
    buffer_store_dwordx4 v[84:87], v82, s[40:43], s50 offen sc1
L_nozero:
L_not7:
    s_waitcnt lgkmcnt(0)
    s_barrier
    s_setprio 2
    ds_read_b128 a[72:75], v4 offset:30720
    ds_read_b128 a[76:79], v4 offset:31744
    ds_read_b128 a[80:83], v4 offset:32768
    ds_read_b128 a[84:87], v4 offset:33792
    ds_read_b128 a[88:91], v4 offset:34816
    ds_read_b128 a[92:95], v4 offset:35840
    s_waitcnt lgkmcnt(5)
    v_mfma_f32_32x32x16_bf16 v[18:33], a[72:75], a[0:3], 0
    s_waitcnt lgkmcnt(4)
    v_mfma_f32_32x32x16_bf16 v[18:33], a[76:79], a[4:7], v[18:33]
    s_waitcnt lgkmcnt(3)
    v_mfma_f32_32x32x16_bf16 v[18:33], a[80:83], a[8:11], v[18:33]
    s_waitcnt lgkmcnt(2)
    v_mfma_f32_32x32x16_bf16 v[18:33], a[84:87], a[12:15], v[18:33]
    s_waitcnt lgkmcnt(1)
    v_mfma_f32_32x32x16_bf16 v[18:33], a[88:91], a[16:19], v[18:33]
    s_waitcnt lgkmcnt(0)
    v_mfma_f32_32x32x16_bf16 v[18:33], a[92:95], a[20:23], v[18:33]
    s_nop 11
    v_pk_fma_f32 v[50:51], v[18:19], v[18:19], s[60:61]
    v_pk_fma_f32 v[52:53], v[20:21], v[20:21], s[60:61]
    buffer_load_dword v118, v9, s[20:23], s72 offen offset:384
    v_pk_fma_f32 v[54:55], v[22:23], v[22:23], s[60:61]
    v_pk_fma_f32 v[56:57], v[24:25], v[24:25], s[60:61]
    v_pk_fma_f32 v[58:59], v[26:27], v[26:27], s[60:61]
    v_pk_fma_f32 v[60:61], v[28:29], v[28:29], s[60:61]
    v_pk_fma_f32 v[62:63], v[30:31], v[30:31], s[60:61]
    v_pk_mul_f32 v[50:51], v[18:19], v[50:51] neg_lo:[1,0] neg_hi:[1,0]
    buffer_load_dword v119, v9, s[20:23], s72 offen offset:576
    v_pk_mul_f32 v[52:53], v[20:21], v[52:53] neg_lo:[1,0] neg_hi:[1,0]
    v_pk_mul_f32 v[54:55], v[22:23], v[54:55] neg_lo:[1,0] neg_hi:[1,0]
    v_pk_mul_f32 v[56:57], v[24:25], v[56:57] neg_lo:[1,0] neg_hi:[1,0]
    v_pk_mul_f32 v[58:59], v[26:27], v[58:59] neg_lo:[1,0] neg_hi:[1,0]
    v_pk_mul_f32 v[60:61], v[28:29], v[60:61] neg_lo:[1,0] neg_hi:[1,0]
    v_pk_mul_f32 v[62:63], v[30:31], v[62:63] neg_lo:[1,0] neg_hi:[1,0]
    v_mfma_f32_32x32x16_bf16 v[34:49], a[72:75], a[24:27], 0
    v_exp_f32 v50, v50
    v_exp_f32 v51, v51
    v_exp_f32 v52, v52
    v_mfma_f32_32x32x16_bf16 v[34:49], a[76:79], a[28:31], v[34:49]
    v_exp_f32 v53, v53
    v_exp_f32 v54, v54
    v_exp_f32 v55, v55
    v_mfma_f32_32x32x16_bf16 v[34:49], a[80:83], a[32:35], v[34:49]
    v_exp_f32 v56, v56
    v_exp_f32 v57, v57
    v_exp_f32 v58, v58
    v_exp_f32 v59, v59
    v_exp_f32 v60, v60
    buffer_load_dword v120, v9, s[20:23], s72 offen offset:3072
    v_exp_f32 v61, v61
    v_exp_f32 v62, v62
    v_exp_f32 v63, v63
    v_pk_add_f32 v[50:51], v[50:51], 1.0 op_sel_hi:[1,0]
    v_pk_add_f32 v[52:53], v[52:53], 1.0 op_sel_hi:[1,0]
    v_pk_add_f32 v[54:55], v[54:55], 1.0 op_sel_hi:[1,0]
    buffer_load_dword v121, v9, s[20:23], s72 offen offset:3264
    v_pk_add_f32 v[56:57], v[56:57], 1.0 op_sel_hi:[1,0]
    v_pk_add_f32 v[58:59], v[58:59], 1.0 op_sel_hi:[1,0]
    v_pk_add_f32 v[60:61], v[60:61], 1.0 op_sel_hi:[1,0]
    v_pk_add_f32 v[62:63], v[62:63], 1.0 op_sel_hi:[1,0]
    v_mfma_f32_32x32x16_bf16 v[34:49], a[84:87], a[36:39], v[34:49]
    v_rcp_f32 v50, v50
    v_rcp_f32 v51, v51
    v_rcp_f32 v52, v52
    v_mfma_f32_32x32x16_bf16 v[34:49], a[88:91], a[40:43], v[34:49]
    v_rcp_f32 v53, v53
    v_rcp_f32 v54, v54
    v_rcp_f32 v55, v55
    v_mfma_f32_32x32x16_bf16 v[34:49], a[92:95], a[44:47], v[34:49]
    v_rcp_f32 v56, v56
    v_rcp_f32 v57, v57
    v_rcp_f32 v58, v58
    v_rcp_f32 v59, v59
    v_rcp_f32 v60, v60
    buffer_load_dword v122, v9, s[20:23], s72 offen offset:3456
    v_rcp_f32 v61, v61
    v_rcp_f32 v62, v62
    v_rcp_f32 v63, v63
    v_pk_mul_f32 v[50:51], v[18:19], v[50:51]
    v_pk_mul_f32 v[52:53], v[20:21], v[52:53]
    v_pk_mul_f32 v[54:55], v[22:23], v[54:55]
    v_pk_mul_f32 v[56:57], v[24:25], v[56:57]
    v_pk_mul_f32 v[58:59], v[26:27], v[58:59]
    v_pk_mul_f32 v[60:61], v[28:29], v[60:61]
    v_pk_mul_f32 v[62:63], v[30:31], v[62:63]
    v_pk_mul_f32 v[12:13], v[50:51], v[50:51]
    v_cvt_pk_bf16_f32 v64, v50, v51
    v_pk_fma_f32 v[12:13], v[52:53], v[52:53], v[12:13]
    v_cvt_pk_bf16_f32 v65, v52, v53
    v_pk_fma_f32 v[12:13], v[54:55], v[54:55], v[12:13]
    v_cvt_pk_bf16_f32 v66, v54, v55
    v_pk_fma_f32 v[12:13], v[56:57], v[56:57], v[12:13]
    v_cvt_pk_bf16_f32 v67, v56, v57
    ds_write_b128 v5, v[64:67] offset:24576
    v_pk_fma_f32 v[12:13], v[58:59], v[58:59], v[12:13]
    v_cvt_pk_bf16_f32 v88, v58, v59
    v_pk_fma_f32 v[12:13], v[60:61], v[60:61], v[12:13]
    v_cvt_pk_bf16_f32 v89, v60, v61
    v_pk_fma_f32 v[12:13], v[62:63], v[62:63], v[12:13]
    v_cvt_pk_bf16_f32 v90, v62, v63
    s_waitcnt lgkmcnt(0)
    s_barrier
    s_setprio 3
    v_pk_fma_f32 v[50:51], v[34:35], v[34:35], s[60:61]
    v_pk_fma_f32 v[52:53], v[36:37], v[36:37], s[60:61]
    buffer_load_dword v123, v9, s[20:23], s72 offen offset:3648
    v_pk_fma_f32 v[54:55], v[38:39], v[38:39], s[60:61]
    v_pk_fma_f32 v[56:57], v[40:41], v[40:41], s[60:61]
    v_pk_fma_f32 v[58:59], v[42:43], v[42:43], s[60:61]
    v_pk_fma_f32 v[60:61], v[44:45], v[44:45], s[60:61]
    v_pk_fma_f32 v[62:63], v[46:47], v[46:47], s[60:61]
    v_pk_mul_f32 v[50:51], v[34:35], v[50:51] neg_lo:[1,0] neg_hi:[1,0]
    buffer_load_dword v124, v9, s[20:23], s70 offen offset:64
    v_pk_mul_f32 v[52:53], v[36:37], v[52:53] neg_lo:[1,0] neg_hi:[1,0]
    v_pk_mul_f32 v[54:55], v[38:39], v[54:55] neg_lo:[1,0] neg_hi:[1,0]
    v_pk_mul_f32 v[56:57], v[40:41], v[56:57] neg_lo:[1,0] neg_hi:[1,0]
    v_pk_mul_f32 v[58:59], v[42:43], v[58:59] neg_lo:[1,0] neg_hi:[1,0]
    v_pk_mul_f32 v[60:61], v[44:45], v[60:61] neg_lo:[1,0] neg_hi:[1,0]
    v_pk_mul_f32 v[62:63], v[46:47], v[62:63] neg_lo:[1,0] neg_hi:[1,0]
    v_mfma_f32_32x32x16_bf16 v[18:33], a[72:75], a[48:51], 0
    v_exp_f32 v50, v50
    v_exp_f32 v51, v51
    v_exp_f32 v52, v52
    v_mfma_f32_32x32x16_bf16 v[18:33], a[76:79], a[52:55], v[18:33]
    v_exp_f32 v53, v53
    v_exp_f32 v54, v54
    v_exp_f32 v55, v55
    v_mfma_f32_32x32x16_bf16 v[18:33], a[80:83], a[56:59], v[18:33]
    v_exp_f32 v56, v56
    v_exp_f32 v57, v57
    v_exp_f32 v58, v58
    v_exp_f32 v59, v59
    v_exp_f32 v60, v60
    buffer_load_dword v125, v9, s[20:23], s70 offen offset:256
    v_exp_f32 v61, v61
    ds_read_b128 a[72:75], v4 offset:43008
    v_exp_f32 v62, v62
    ds_read_b128 a[76:79], v4 offset:44032
    v_exp_f32 v63, v63
    ds_read_b128 a[80:83], v4 offset:45056
    v_pk_add_f32 v[50:51], v[50:51], 1.0 op_sel_hi:[1,0]
    v_pk_add_f32 v[52:53], v[52:53], 1.0 op_sel_hi:[1,0]
    v_pk_add_f32 v[54:55], v[54:55], 1.0 op_sel_hi:[1,0]
    buffer_load_dword v126, v9, s[20:23], s70 offen offset:448
    v_pk_add_f32 v[56:57], v[56:57], 1.0 op_sel_hi:[1,0]
    v_pk_add_f32 v[58:59], v[58:59], 1.0 op_sel_hi:[1,0]
    v_pk_add_f32 v[60:61], v[60:61], 1.0 op_sel_hi:[1,0]
    v_pk_add_f32 v[62:63], v[62:63], 1.0 op_sel_hi:[1,0]
    v_mfma_f32_32x32x16_bf16 v[18:33], a[84:87], a[60:63], v[18:33]
    v_rcp_f32 v50, v50
    v_rcp_f32 v51, v51
    v_rcp_f32 v52, v52
    v_mfma_f32_32x32x16_bf16 v[18:33], a[88:91], a[64:67], v[18:33]
    v_rcp_f32 v53, v53
    v_rcp_f32 v54, v54
    v_rcp_f32 v55, v55
    v_mfma_f32_32x32x16_bf16 v[18:33], a[92:95], a[68:71], v[18:33]
    v_rcp_f32 v56, v56
    v_rcp_f32 v57, v57
    v_rcp_f32 v58, v58
    v_rcp_f32 v59, v59
    v_rcp_f32 v60, v60
    buffer_load_dword v127, v9, s[20:23], s70 offen offset:640
    v_rcp_f32 v61, v61
    ds_read_b128 a[84:87], v4 offset:46080
    v_rcp_f32 v62, v62
    ds_read_b128 a[88:91], v4 offset:47104
    v_rcp_f32 v63, v63
    ds_read_b128 a[92:95], v4 offset:48128
    v_pk_mul_f32 v[50:51], v[34:35], v[50:51]
    v_pk_mul_f32 v[52:53], v[36:37], v[52:53]
    v_pk_mul_f32 v[54:55], v[38:39], v[54:55]
    v_pk_mul_f32 v[56:57], v[40:41], v[56:57]
    v_pk_mul_f32 v[58:59], v[42:43], v[58:59]
    v_pk_mul_f32 v[60:61], v[44:45], v[60:61]
    v_pk_mul_f32 v[62:63], v[46:47], v[62:63]
    v_pk_mul_f32 v[14:15], v[50:51], v[50:51]
    v_cvt_pk_bf16_f32 v68, v50, v51
    v_pk_fma_f32 v[14:15], v[52:53], v[52:53], v[14:15]
    v_cvt_pk_bf16_f32 v69, v52, v53
    v_pk_fma_f32 v[14:15], v[54:55], v[54:55], v[14:15]
    v_cvt_pk_bf16_f32 v70, v54, v55
    v_pk_fma_f32 v[14:15], v[56:57], v[56:57], v[14:15]
    v_cvt_pk_bf16_f32 v71, v56, v57
    ds_write_b128 v5, v[68:71] offset:25600
    v_pk_fma_f32 v[14:15], v[58:59], v[58:59], v[14:15]
    v_cvt_pk_bf16_f32 v92, v58, v59
    v_pk_fma_f32 v[14:15], v[60:61], v[60:61], v[14:15]
    v_cvt_pk_bf16_f32 v93, v60, v61
    v_pk_fma_f32 v[14:15], v[62:63], v[62:63], v[14:15]
    v_cvt_pk_bf16_f32 v94, v62, v63
    v_pk_fma_f32 v[50:51], v[18:19], v[18:19], s[60:61]
    v_pk_fma_f32 v[52:53], v[20:21], v[20:21], s[60:61]
    buffer_load_dword v128, v9, s[20:23], s70 offen offset:3136
    v_pk_fma_f32 v[54:55], v[22:23], v[22:23], s[60:61]
    v_pk_fma_f32 v[56:57], v[24:25], v[24:25], s[60:61]
    v_pk_fma_f32 v[58:59], v[26:27], v[26:27], s[60:61]
    v_pk_fma_f32 v[60:61], v[28:29], v[28:29], s[60:61]
    v_pk_fma_f32 v[62:63], v[30:31], v[30:31], s[60:61]
    v_pk_mul_f32 v[50:51], v[18:19], v[50:51] neg_lo:[1,0] neg_hi:[1,0]
    buffer_load_dword v129, v9, s[20:23], s70 offen offset:3328
    v_pk_mul_f32 v[52:53], v[20:21], v[52:53] neg_lo:[1,0] neg_hi:[1,0]
    v_pk_mul_f32 v[54:55], v[22:23], v[54:55] neg_lo:[1,0] neg_hi:[1,0]
    v_pk_mul_f32 v[56:57], v[24:25], v[56:57] neg_lo:[1,0] neg_hi:[1,0]
    v_pk_mul_f32 v[58:59], v[26:27], v[58:59] neg_lo:[1,0] neg_hi:[1,0]
    v_pk_mul_f32 v[60:61], v[28:29], v[60:61] neg_lo:[1,0] neg_hi:[1,0]
    v_pk_mul_f32 v[62:63], v[30:31], v[62:63] neg_lo:[1,0] neg_hi:[1,0]
    s_waitcnt lgkmcnt(6)
    v_mfma_f32_32x32x16_bf16 v[34:49], a[72:75], a[0:3], 0
    v_exp_f32 v50, v50
    v_exp_f32 v51, v51
    v_exp_f32 v52, v52
    s_waitcnt lgkmcnt(5)
    v_mfma_f32_32x32x16_bf16 v[34:49], a[76:79], a[4:7], v[34:49]
    v_exp_f32 v53, v53
    v_exp_f32 v54, v54
    v_exp_f32 v55, v55
    s_waitcnt lgkmcnt(4)
    v_mfma_f32_32x32x16_bf16 v[34:49], a[80:83], a[8:11], v[34:49]
    v_exp_f32 v56, v56
    v_exp_f32 v57, v57
    v_exp_f32 v58, v58
    v_exp_f32 v59, v59
    v_exp_f32 v60, v60
    buffer_load_dword v130, v9, s[20:23], s70 offen offset:3520
    v_exp_f32 v61, v61
    v_exp_f32 v62, v62
    v_exp_f32 v63, v63
    v_pk_add_f32 v[50:51], v[50:51], 1.0 op_sel_hi:[1,0]
    v_pk_add_f32 v[52:53], v[52:53], 1.0 op_sel_hi:[1,0]
    v_pk_add_f32 v[54:55], v[54:55], 1.0 op_sel_hi:[1,0]
    buffer_load_dword v131, v9, s[20:23], s70 offen offset:3712
    v_pk_add_f32 v[56:57], v[56:57], 1.0 op_sel_hi:[1,0]
    v_pk_add_f32 v[58:59], v[58:59], 1.0 op_sel_hi:[1,0]
    v_pk_add_f32 v[60:61], v[60:61], 1.0 op_sel_hi:[1,0]
    v_pk_add_f32 v[62:63], v[62:63], 1.0 op_sel_hi:[1,0]
    s_waitcnt lgkmcnt(3)
    v_mfma_f32_32x32x16_bf16 v[34:49], a[84:87], a[12:15], v[34:49]
    v_rcp_f32 v50, v50
    v_rcp_f32 v51, v51
    v_rcp_f32 v52, v52
    s_waitcnt lgkmcnt(2)
    v_mfma_f32_32x32x16_bf16 v[34:49], a[88:91], a[16:19], v[34:49]
    v_rcp_f32 v53, v53
    v_rcp_f32 v54, v54
    v_rcp_f32 v55, v55
    s_waitcnt lgkmcnt(1)
    v_mfma_f32_32x32x16_bf16 v[34:49], a[92:95], a[20:23], v[34:49]
    v_rcp_f32 v56, v56
    v_rcp_f32 v57, v57
    v_rcp_f32 v58, v58
    v_rcp_f32 v59, v59
    v_rcp_f32 v60, v60
    buffer_load_dword v132, v9, s[20:23], s71 offen offset:64
    v_rcp_f32 v61, v61
    v_rcp_f32 v62, v62
    v_rcp_f32 v63, v63
    v_pk_mul_f32 v[50:51], v[18:19], v[50:51]
    v_pk_mul_f32 v[52:53], v[20:21], v[52:53]
    v_pk_mul_f32 v[54:55], v[22:23], v[54:55]
    v_pk_mul_f32 v[56:57], v[24:25], v[56:57]
    v_pk_mul_f32 v[58:59], v[26:27], v[58:59]
    v_pk_mul_f32 v[60:61], v[28:29], v[60:61]
    v_pk_mul_f32 v[62:63], v[30:31], v[62:63]
    v_pk_mul_f32 v[16:17], v[50:51], v[50:51]
    v_cvt_pk_bf16_f32 v72, v50, v51
    v_pk_fma_f32 v[16:17], v[52:53], v[52:53], v[16:17]
    v_cvt_pk_bf16_f32 v73, v52, v53
    v_pk_fma_f32 v[16:17], v[54:55], v[54:55], v[16:17]
    v_cvt_pk_bf16_f32 v74, v54, v55
    v_pk_fma_f32 v[16:17], v[56:57], v[56:57], v[16:17]
    v_cvt_pk_bf16_f32 v75, v56, v57
    ds_write_b128 v5, v[72:75] offset:26624
    v_pk_fma_f32 v[16:17], v[58:59], v[58:59], v[16:17]
    v_cvt_pk_bf16_f32 v96, v58, v59
    v_pk_fma_f32 v[16:17], v[60:61], v[60:61], v[16:17]
    v_cvt_pk_bf16_f32 v97, v60, v61
    v_pk_fma_f32 v[16:17], v[62:63], v[62:63], v[16:17]
    v_cvt_pk_bf16_f32 v98, v62, v63
    s_setprio 2
    v_pk_fma_f32 v[50:51], v[34:35], v[34:35], s[60:61]
    s_cmp_lt_u32 s2, 16
    s_cselect_b32 s48, s44, 0
    s_cmp_lg_u32 s48, 7
    s_cbranch_scc1 L_nosignal
    s_waitcnt vmcnt(0)
    v_mov_b32 v11, 1
    s_mov_b64 exec, 1
    buffer_atomic_add v11, off, s[36:39], 0
    s_mov_b64 exec, -1
L_nosignal:
    v_pk_fma_f32 v[52:53], v[36:37], v[36:37], s[60:61]
    buffer_load_dword v133, v9, s[20:23], s71 offen offset:256
    v_pk_fma_f32 v[54:55], v[38:39], v[38:39], s[60:61]
    v_pk_fma_f32 v[56:57], v[40:41], v[40:41], s[60:61]
    v_pk_fma_f32 v[58:59], v[42:43], v[42:43], s[60:61]
    v_pk_fma_f32 v[60:61], v[44:45], v[44:45], s[60:61]
    v_pk_fma_f32 v[62:63], v[46:47], v[46:47], s[60:61]
    v_pk_mul_f32 v[50:51], v[34:35], v[50:51] neg_lo:[1,0] neg_hi:[1,0]
    buffer_load_dword v134, v9, s[20:23], s71 offen offset:448
    v_pk_mul_f32 v[52:53], v[36:37], v[52:53] neg_lo:[1,0] neg_hi:[1,0]
    v_pk_mul_f32 v[54:55], v[38:39], v[54:55] neg_lo:[1,0] neg_hi:[1,0]
    v_pk_mul_f32 v[56:57], v[40:41], v[56:57] neg_lo:[1,0] neg_hi:[1,0]
    v_pk_mul_f32 v[58:59], v[42:43], v[58:59] neg_lo:[1,0] neg_hi:[1,0]
    v_pk_mul_f32 v[60:61], v[44:45], v[60:61] neg_lo:[1,0] neg_hi:[1,0]
    v_pk_mul_f32 v[62:63], v[46:47], v[62:63] neg_lo:[1,0] neg_hi:[1,0]
    v_mfma_f32_32x32x16_bf16 v[18:33], a[72:75], a[24:27], 0
    v_exp_f32 v50, v50
    v_exp_f32 v51, v51
    v_exp_f32 v52, v52
    v_mfma_f32_32x32x16_bf16 v[18:33], a[76:79], a[28:31], v[18:33]
    v_exp_f32 v53, v53
    v_exp_f32 v54, v54
    v_exp_f32 v55, v55
    v_mfma_f32_32x32x16_bf16 v[18:33], a[80:83], a[32:35], v[18:33]
    v_exp_f32 v56, v56
    v_exp_f32 v57, v57
    v_exp_f32 v58, v58
    v_exp_f32 v59, v59
    v_exp_f32 v60, v60
    buffer_load_dword v135, v9, s[20:23], s71 offen offset:640
    v_exp_f32 v61, v61
    v_exp_f32 v62, v62
    v_exp_f32 v63, v63
    v_pk_add_f32 v[50:51], v[50:51], 1.0 op_sel_hi:[1,0]
    v_pk_add_f32 v[52:53], v[52:53], 1.0 op_sel_hi:[1,0]
    v_pk_add_f32 v[54:55], v[54:55], 1.0 op_sel_hi:[1,0]
    buffer_load_dword v136, v9, s[20:23], s71 offen offset:3136
    v_pk_add_f32 v[56:57], v[56:57], 1.0 op_sel_hi:[1,0]
    v_pk_add_f32 v[58:59], v[58:59], 1.0 op_sel_hi:[1,0]
    v_pk_add_f32 v[60:61], v[60:61], 1.0 op_sel_hi:[1,0]
    v_pk_add_f32 v[62:63], v[62:63], 1.0 op_sel_hi:[1,0]
    v_mfma_f32_32x32x16_bf16 v[18:33], a[84:87], a[36:39], v[18:33]
    v_rcp_f32 v50, v50
    v_rcp_f32 v51, v51
    v_rcp_f32 v52, v52
    v_mfma_f32_32x32x16_bf16 v[18:33], a[88:91], a[40:43], v[18:33]
    v_rcp_f32 v53, v53
    v_rcp_f32 v54, v54
    v_rcp_f32 v55, v55
    v_mfma_f32_32x32x16_bf16 v[18:33], a[92:95], a[44:47], v[18:33]
    v_rcp_f32 v56, v56
    v_rcp_f32 v57, v57
    v_rcp_f32 v58, v58
    v_rcp_f32 v59, v59
    v_rcp_f32 v60, v60
    buffer_load_dword v137, v9, s[20:23], s71 offen offset:3328
    v_rcp_f32 v61, v61
    v_rcp_f32 v62, v62
    v_rcp_f32 v63, v63
    v_pk_mul_f32 v[50:51], v[34:35], v[50:51]
    v_pk_mul_f32 v[52:53], v[36:37], v[52:53]
    v_pk_mul_f32 v[54:55], v[38:39], v[54:55]
    v_pk_mul_f32 v[56:57], v[40:41], v[56:57]
    v_pk_mul_f32 v[58:59], v[42:43], v[58:59]
    v_pk_mul_f32 v[60:61], v[44:45], v[60:61]
    v_pk_mul_f32 v[62:63], v[46:47], v[62:63]
    v_pk_fma_f32 v[12:13], v[50:51], v[50:51], v[12:13]
    v_cvt_pk_bf16_f32 v64, v50, v51
    v_pk_fma_f32 v[12:13], v[52:53], v[52:53], v[12:13]
    v_cvt_pk_bf16_f32 v65, v52, v53
    v_pk_fma_f32 v[12:13], v[54:55], v[54:55], v[12:13]
    v_cvt_pk_bf16_f32 v66, v54, v55
    v_pk_fma_f32 v[12:13], v[56:57], v[56:57], v[12:13]
    v_cvt_pk_bf16_f32 v67, v56, v57
    ds_write_b128 v6, v[64:67] offset:24576
    v_pk_fma_f32 v[12:13], v[58:59], v[58:59], v[12:13]
    v_cvt_pk_bf16_f32 v91, v58, v59
    ds_write_b128 v6, v[88:91] offset:61440
    v_pk_fma_f32 v[12:13], v[60:61], v[60:61], v[12:13]
    v_cvt_pk_bf16_f32 v76, v60, v61
    v_pk_fma_f32 v[12:13], v[62:63], v[62:63], v[12:13]
    v_cvt_pk_bf16_f32 v77, v62, v63
    v_add_u32 v4, 122880, v4
    v_pk_fma_f32 v[50:51], v[18:19], v[18:19], s[60:61]
    v_pk_fma_f32 v[52:53], v[20:21], v[20:21], s[60:61]
    buffer_load_dword v138, v9, s[20:23], s71 offen offset:3520
    v_pk_fma_f32 v[54:55], v[22:23], v[22:23], s[60:61]
    v_pk_fma_f32 v[56:57], v[24:25], v[24:25], s[60:61]
    v_pk_fma_f32 v[58:59], v[26:27], v[26:27], s[60:61]
    v_pk_fma_f32 v[60:61], v[28:29], v[28:29], s[60:61]
    v_pk_fma_f32 v[62:63], v[30:31], v[30:31], s[60:61]
    v_pk_mul_f32 v[50:51], v[18:19], v[50:51] neg_lo:[1,0] neg_hi:[1,0]
    buffer_load_dword v139, v9, s[20:23], s71 offen offset:3712
    v_pk_mul_f32 v[52:53], v[20:21], v[52:53] neg_lo:[1,0] neg_hi:[1,0]
    v_pk_mul_f32 v[54:55], v[22:23], v[54:55] neg_lo:[1,0] neg_hi:[1,0]
    v_pk_mul_f32 v[56:57], v[24:25], v[56:57] neg_lo:[1,0] neg_hi:[1,0]
    v_pk_mul_f32 v[58:59], v[26:27], v[58:59] neg_lo:[1,0] neg_hi:[1,0]
    v_pk_mul_f32 v[60:61], v[28:29], v[60:61] neg_lo:[1,0] neg_hi:[1,0]
    v_pk_mul_f32 v[62:63], v[30:31], v[62:63] neg_lo:[1,0] neg_hi:[1,0]
    v_mfma_f32_32x32x16_bf16 v[34:49], a[72:75], a[48:51], 0
    v_exp_f32 v50, v50
    v_exp_f32 v51, v51
    v_exp_f32 v52, v52
    v_mfma_f32_32x32x16_bf16 v[34:49], a[76:79], a[52:55], v[34:49]
    v_exp_f32 v53, v53
    v_exp_f32 v54, v54
    v_exp_f32 v55, v55
    v_mfma_f32_32x32x16_bf16 v[34:49], a[80:83], a[56:59], v[34:49]
    v_exp_f32 v56, v56
    v_exp_f32 v57, v57
    v_exp_f32 v58, v58
    v_exp_f32 v59, v59
    v_exp_f32 v60, v60
    buffer_load_dword v140, v9, s[20:23], s72 offen offset:64
    v_exp_f32 v61, v61
    ds_read_b128 a[72:75], v4 offset:6144
    v_exp_f32 v62, v62
    ds_read_b128 a[76:79], v4 offset:7168
    v_exp_f32 v63, v63
    ds_read_b128 a[80:83], v4 offset:8192
    v_pk_add_f32 v[50:51], v[50:51], 1.0 op_sel_hi:[1,0]
    v_pk_add_f32 v[52:53], v[52:53], 1.0 op_sel_hi:[1,0]
    v_pk_add_f32 v[54:55], v[54:55], 1.0 op_sel_hi:[1,0]
    buffer_load_dword v141, v9, s[20:23], s72 offen offset:256
    v_pk_add_f32 v[56:57], v[56:57], 1.0 op_sel_hi:[1,0]
    v_pk_add_f32 v[58:59], v[58:59], 1.0 op_sel_hi:[1,0]
    v_pk_add_f32 v[60:61], v[60:61], 1.0 op_sel_hi:[1,0]
    v_pk_add_f32 v[62:63], v[62:63], 1.0 op_sel_hi:[1,0]
    v_mfma_f32_32x32x16_bf16 v[34:49], a[84:87], a[60:63], v[34:49]
    v_rcp_f32 v50, v50
    v_rcp_f32 v51, v51
    v_rcp_f32 v52, v52
    v_mfma_f32_32x32x16_bf16 v[34:49], a[88:91], a[64:67], v[34:49]
    v_rcp_f32 v53, v53
    v_rcp_f32 v54, v54
    v_rcp_f32 v55, v55
    v_mfma_f32_32x32x16_bf16 v[34:49], a[92:95], a[68:71], v[34:49]
    v_rcp_f32 v56, v56
    v_rcp_f32 v57, v57
    v_rcp_f32 v58, v58
    v_rcp_f32 v59, v59
    v_rcp_f32 v60, v60
    buffer_load_dword v142, v9, s[20:23], s72 offen offset:448
    v_rcp_f32 v61, v61
    ds_read_b128 a[84:87], v4 offset:9216
    v_rcp_f32 v62, v62
    ds_read_b128 a[88:91], v4 offset:10240
    v_rcp_f32 v63, v63
    ds_read_b128 a[92:95], v4 offset:11264
    v_pk_mul_f32 v[50:51], v[18:19], v[50:51]
    v_pk_mul_f32 v[52:53], v[20:21], v[52:53]
    v_pk_mul_f32 v[54:55], v[22:23], v[54:55]
    v_pk_mul_f32 v[56:57], v[24:25], v[56:57]
    v_pk_mul_f32 v[58:59], v[26:27], v[58:59]
    v_pk_mul_f32 v[60:61], v[28:29], v[60:61]
    v_pk_mul_f32 v[62:63], v[30:31], v[62:63]
    v_pk_fma_f32 v[14:15], v[50:51], v[50:51], v[14:15]
    v_cvt_pk_bf16_f32 v68, v50, v51
    v_pk_fma_f32 v[14:15], v[52:53], v[52:53], v[14:15]
    v_cvt_pk_bf16_f32 v69, v52, v53
    v_pk_fma_f32 v[14:15], v[54:55], v[54:55], v[14:15]
    v_cvt_pk_bf16_f32 v70, v54, v55
    v_pk_fma_f32 v[14:15], v[56:57], v[56:57], v[14:15]
    v_cvt_pk_bf16_f32 v71, v56, v57
    ds_write_b128 v6, v[68:71] offset:25600
    v_pk_fma_f32 v[14:15], v[58:59], v[58:59], v[14:15]
    v_cvt_pk_bf16_f32 v95, v58, v59
    ds_write_b128 v6, v[92:95] offset:62464
    v_pk_fma_f32 v[14:15], v[60:61], v[60:61], v[14:15]
    v_cvt_pk_bf16_f32 v80, v60, v61
    v_pk_fma_f32 v[14:15], v[62:63], v[62:63], v[14:15]
    v_cvt_pk_bf16_f32 v81, v62, v63
    v_pk_fma_f32 v[50:51], v[34:35], v[34:35], s[60:61]
    v_pk_fma_f32 v[52:53], v[36:37], v[36:37], s[60:61]
    buffer_load_dword v143, v9, s[20:23], s72 offen offset:640
    v_pk_fma_f32 v[54:55], v[38:39], v[38:39], s[60:61]
    v_pk_fma_f32 v[56:57], v[40:41], v[40:41], s[60:61]
    v_pk_fma_f32 v[58:59], v[42:43], v[42:43], s[60:61]
    v_pk_fma_f32 v[60:61], v[44:45], v[44:45], s[60:61]
    v_pk_fma_f32 v[62:63], v[46:47], v[46:47], s[60:61]
    v_pk_mul_f32 v[50:51], v[34:35], v[50:51] neg_lo:[1,0] neg_hi:[1,0]
    buffer_load_dword v144, v9, s[20:23], s72 offen offset:3136
    v_pk_mul_f32 v[52:53], v[36:37], v[52:53] neg_lo:[1,0] neg_hi:[1,0]
    v_pk_mul_f32 v[54:55], v[38:39], v[54:55] neg_lo:[1,0] neg_hi:[1,0]
    v_pk_mul_f32 v[56:57], v[40:41], v[56:57] neg_lo:[1,0] neg_hi:[1,0]
    v_pk_mul_f32 v[58:59], v[42:43], v[58:59] neg_lo:[1,0] neg_hi:[1,0]
    v_pk_mul_f32 v[60:61], v[44:45], v[60:61] neg_lo:[1,0] neg_hi:[1,0]
    v_pk_mul_f32 v[62:63], v[46:47], v[62:63] neg_lo:[1,0] neg_hi:[1,0]
    s_waitcnt lgkmcnt(7)
    v_mfma_f32_32x32x16_bf16 v[18:33], a[72:75], a[0:3], 0
    v_exp_f32 v50, v50
    v_exp_f32 v51, v51
    v_exp_f32 v52, v52
    s_waitcnt lgkmcnt(6)
    v_mfma_f32_32x32x16_bf16 v[18:33], a[76:79], a[4:7], v[18:33]
    v_exp_f32 v53, v53
    v_exp_f32 v54, v54
    v_exp_f32 v55, v55
    s_waitcnt lgkmcnt(5)
    v_mfma_f32_32x32x16_bf16 v[18:33], a[80:83], a[8:11], v[18:33]
    v_exp_f32 v56, v56
    v_exp_f32 v57, v57
    v_exp_f32 v58, v58
    v_exp_f32 v59, v59
    v_exp_f32 v60, v60
    buffer_load_dword v145, v9, s[20:23], s72 offen offset:3328
    v_exp_f32 v61, v61
    v_exp_f32 v62, v62
    v_exp_f32 v63, v63
    v_pk_add_f32 v[50:51], v[50:51], 1.0 op_sel_hi:[1,0]
    v_pk_add_f32 v[52:53], v[52:53], 1.0 op_sel_hi:[1,0]
    v_pk_add_f32 v[54:55], v[54:55], 1.0 op_sel_hi:[1,0]
    buffer_load_dword v146, v9, s[20:23], s72 offen offset:3520
    v_pk_add_f32 v[56:57], v[56:57], 1.0 op_sel_hi:[1,0]
    v_pk_add_f32 v[58:59], v[58:59], 1.0 op_sel_hi:[1,0]
    v_pk_add_f32 v[60:61], v[60:61], 1.0 op_sel_hi:[1,0]
    v_pk_add_f32 v[62:63], v[62:63], 1.0 op_sel_hi:[1,0]
    s_waitcnt lgkmcnt(4)
    v_mfma_f32_32x32x16_bf16 v[18:33], a[84:87], a[12:15], v[18:33]
    v_rcp_f32 v50, v50
    v_rcp_f32 v51, v51
    v_rcp_f32 v52, v52
    s_waitcnt lgkmcnt(3)
    v_mfma_f32_32x32x16_bf16 v[18:33], a[88:91], a[16:19], v[18:33]
    v_rcp_f32 v53, v53
    v_rcp_f32 v54, v54
    v_rcp_f32 v55, v55
    s_waitcnt lgkmcnt(2)
    v_mfma_f32_32x32x16_bf16 v[18:33], a[92:95], a[20:23], v[18:33]
    v_rcp_f32 v56, v56
    v_rcp_f32 v57, v57
    v_rcp_f32 v58, v58
    v_rcp_f32 v59, v59
    v_rcp_f32 v60, v60
    buffer_load_dword v147, v9, s[20:23], s72 offen offset:3712
    v_rcp_f32 v61, v61
    v_rcp_f32 v62, v62
    v_rcp_f32 v63, v63
    v_pk_mul_f32 v[50:51], v[34:35], v[50:51]
    v_pk_mul_f32 v[52:53], v[36:37], v[52:53]
    v_pk_mul_f32 v[54:55], v[38:39], v[54:55]
    v_pk_mul_f32 v[56:57], v[40:41], v[56:57]
    v_pk_mul_f32 v[58:59], v[42:43], v[58:59]
    v_pk_mul_f32 v[60:61], v[44:45], v[60:61]
    v_pk_mul_f32 v[62:63], v[46:47], v[62:63]
    v_pk_fma_f32 v[16:17], v[50:51], v[50:51], v[16:17]
    v_cvt_pk_bf16_f32 v72, v50, v51
    v_pk_fma_f32 v[16:17], v[52:53], v[52:53], v[16:17]
    v_cvt_pk_bf16_f32 v73, v52, v53
    v_pk_fma_f32 v[16:17], v[54:55], v[54:55], v[16:17]
    v_cvt_pk_bf16_f32 v74, v54, v55
    v_pk_fma_f32 v[16:17], v[56:57], v[56:57], v[16:17]
    v_cvt_pk_bf16_f32 v75, v56, v57
    ds_write_b128 v6, v[72:75] offset:26624
    v_pk_fma_f32 v[16:17], v[58:59], v[58:59], v[16:17]
    v_cvt_pk_bf16_f32 v99, v58, v59
    ds_write_b128 v6, v[96:99] offset:63488
    v_pk_fma_f32 v[16:17], v[60:61], v[60:61], v[16:17]
    v_cvt_pk_bf16_f32 v84, v60, v61
    v_pk_fma_f32 v[16:17], v[62:63], v[62:63], v[16:17]
    v_cvt_pk_bf16_f32 v85, v62, v63
    s_setprio 1
    v_pk_fma_f32 v[50:51], v[18:19], v[18:19], s[60:61]
    s_waitcnt lgkmcnt(0)
    v_pk_fma_f32 v[52:53], v[20:21], v[20:21], s[60:61]
    buffer_load_dword a0, v9, s[20:23], s70 offen offset:128
    v_pk_fma_f32 v[54:55], v[22:23], v[22:23], s[60:61]
    v_pk_fma_f32 v[56:57], v[24:25], v[24:25], s[60:61]
    v_pk_fma_f32 v[58:59], v[26:27], v[26:27], s[60:61]
    buffer_load_dword a1, v9, s[20:23], s70 offen offset:320
    v_pk_fma_f32 v[60:61], v[28:29], v[28:29], s[60:61]
    v_pk_fma_f32 v[62:63], v[30:31], v[30:31], s[60:61]
    v_pk_mul_f32 v[50:51], v[18:19], v[50:51] neg_lo:[1,0] neg_hi:[1,0]
    buffer_load_dword a2, v9, s[20:23], s70 offen offset:512
    v_pk_mul_f32 v[52:53], v[20:21], v[52:53] neg_lo:[1,0] neg_hi:[1,0]
    v_pk_mul_f32 v[54:55], v[22:23], v[54:55] neg_lo:[1,0] neg_hi:[1,0]
    v_pk_mul_f32 v[56:57], v[24:25], v[56:57] neg_lo:[1,0] neg_hi:[1,0]
    buffer_load_dword a3, v9, s[20:23], s70 offen offset:704
    v_pk_mul_f32 v[58:59], v[26:27], v[58:59] neg_lo:[1,0] neg_hi:[1,0]
    v_pk_mul_f32 v[60:61], v[28:29], v[60:61] neg_lo:[1,0] neg_hi:[1,0]
    v_pk_mul_f32 v[62:63], v[30:31], v[62:63] neg_lo:[1,0] neg_hi:[1,0]
    v_mfma_f32_32x32x16_bf16 v[34:49], a[72:75], a[24:27], 0
    v_exp_f32 v50, v50
    v_exp_f32 v51, v51
    v_exp_f32 v52, v52
    v_mfma_f32_32x32x16_bf16 v[34:49], a[76:79], a[28:31], v[34:49]
    v_exp_f32 v53, v53
    v_exp_f32 v54, v54
    v_exp_f32 v55, v55
    v_mfma_f32_32x32x16_bf16 v[34:49], a[80:83], a[32:35], v[34:49]
    v_exp_f32 v56, v56
    v_exp_f32 v57, v57
    v_exp_f32 v58, v58
    v_exp_f32 v59, v59
    v_exp_f32 v60, v60
    buffer_load_dword a4, v9, s[20:23], s70 offen offset:3200
    v_exp_f32 v61, v61
    v_exp_f32 v62, v62
    buffer_load_dword a5, v9, s[20:23], s70 offen offset:3392
    v_exp_f32 v63, v63
    v_pk_add_f32 v[50:51], v[50:51], 1.0 op_sel_hi:[1,0]
    v_pk_add_f32 v[52:53], v[52:53], 1.0 op_sel_hi:[1,0]
    v_pk_add_f32 v[54:55], v[54:55], 1.0 op_sel_hi:[1,0]
    buffer_load_dword a6, v9, s[20:23], s70 offen offset:3584
    v_pk_add_f32 v[56:57], v[56:57], 1.0 op_sel_hi:[1,0]
    v_pk_add_f32 v[58:59], v[58:59], 1.0 op_sel_hi:[1,0]
    v_pk_add_f32 v[60:61], v[60:61], 1.0 op_sel_hi:[1,0]
    buffer_load_dword a7, v9, s[20:23], s70 offen offset:3776
    v_pk_add_f32 v[62:63], v[62:63], 1.0 op_sel_hi:[1,0]
    v_mfma_f32_32x32x16_bf16 v[34:49], a[84:87], a[36:39], v[34:49]
    v_rcp_f32 v50, v50
    v_rcp_f32 v51, v51
    v_rcp_f32 v52, v52
    v_mfma_f32_32x32x16_bf16 v[34:49], a[88:91], a[40:43], v[34:49]
    v_rcp_f32 v53, v53
    v_rcp_f32 v54, v54
    v_rcp_f32 v55, v55
    v_mfma_f32_32x32x16_bf16 v[34:49], a[92:95], a[44:47], v[34:49]
    v_rcp_f32 v56, v56
    v_rcp_f32 v57, v57
    v_rcp_f32 v58, v58
    v_rcp_f32 v59, v59
    v_rcp_f32 v60, v60
    buffer_load_dword a8, v9, s[20:23], s71 offen offset:128
    v_rcp_f32 v61, v61
    v_rcp_f32 v62, v62
    buffer_load_dword a9, v9, s[20:23], s71 offen offset:320
    v_rcp_f32 v63, v63
    v_pk_mul_f32 v[50:51], v[18:19], v[50:51]
    v_pk_mul_f32 v[52:53], v[20:21], v[52:53]
    v_pk_mul_f32 v[54:55], v[22:23], v[54:55]
    v_pk_mul_f32 v[56:57], v[24:25], v[56:57]
    v_pk_mul_f32 v[58:59], v[26:27], v[58:59]
    v_pk_mul_f32 v[60:61], v[28:29], v[60:61]
    v_pk_mul_f32 v[62:63], v[30:31], v[62:63]
    v_pk_fma_f32 v[12:13], v[50:51], v[50:51], v[12:13]
    v_cvt_pk_bf16_f32 v64, v50, v51
    v_pk_fma_f32 v[12:13], v[52:53], v[52:53], v[12:13]
    v_cvt_pk_bf16_f32 v65, v52, v53
    v_pk_fma_f32 v[12:13], v[54:55], v[54:55], v[12:13]
    v_cvt_pk_bf16_f32 v66, v54, v55
    v_pk_fma_f32 v[12:13], v[56:57], v[56:57], v[12:13]
    v_cvt_pk_bf16_f32 v67, v56, v57
    v_pk_fma_f32 v[12:13], v[58:59], v[58:59], v[12:13]
    v_cvt_pk_bf16_f32 v78, v58, v59
    v_pk_fma_f32 v[12:13], v[60:61], v[60:61], v[12:13]
    v_cvt_pk_bf16_f32 v79, v60, v61
    v_pk_fma_f32 v[12:13], v[62:63], v[62:63], v[12:13]
    v_cvt_pk_bf16_f32 v11, v62, v63
    ds_write_b32 v8, v11 offset:0
    v_pk_fma_f32 v[50:51], v[34:35], v[34:35], s[60:61]
    v_pk_fma_f32 v[52:53], v[36:37], v[36:37], s[60:61]
    buffer_load_dword a10, v9, s[20:23], s71 offen offset:512
    v_pk_fma_f32 v[54:55], v[38:39], v[38:39], s[60:61]
    v_pk_fma_f32 v[56:57], v[40:41], v[40:41], s[60:61]
    v_pk_fma_f32 v[58:59], v[42:43], v[42:43], s[60:61]
    buffer_load_dword a11, v9, s[20:23], s71 offen offset:704
    v_pk_fma_f32 v[60:61], v[44:45], v[44:45], s[60:61]
    v_pk_fma_f32 v[62:63], v[46:47], v[46:47], s[60:61]
    v_pk_mul_f32 v[50:51], v[34:35], v[50:51] neg_lo:[1,0] neg_hi:[1,0]
    buffer_load_dword a12, v9, s[20:23], s71 offen offset:3200
    v_pk_mul_f32 v[52:53], v[36:37], v[52:53] neg_lo:[1,0] neg_hi:[1,0]
    v_pk_mul_f32 v[54:55], v[38:39], v[54:55] neg_lo:[1,0] neg_hi:[1,0]
    v_pk_mul_f32 v[56:57], v[40:41], v[56:57] neg_lo:[1,0] neg_hi:[1,0]
    buffer_load_dword a13, v9, s[20:23], s71 offen offset:3392
    v_pk_mul_f32 v[58:59], v[42:43], v[58:59] neg_lo:[1,0] neg_hi:[1,0]
    v_pk_mul_f32 v[60:61], v[44:45], v[60:61] neg_lo:[1,0] neg_hi:[1,0]
    v_pk_mul_f32 v[62:63], v[46:47], v[62:63] neg_lo:[1,0] neg_hi:[1,0]
    v_mfma_f32_32x32x16_bf16 v[18:33], a[72:75], a[48:51], 0
    v_exp_f32 v50, v50
    v_exp_f32 v51, v51
    v_exp_f32 v52, v52
    v_mfma_f32_32x32x16_bf16 v[18:33], a[76:79], a[52:55], v[18:33]
    v_exp_f32 v53, v53
    v_exp_f32 v54, v54
    v_exp_f32 v55, v55
    v_mfma_f32_32x32x16_bf16 v[18:33], a[80:83], a[56:59], v[18:33]
    v_exp_f32 v56, v56
    v_exp_f32 v57, v57
    v_exp_f32 v58, v58
    v_exp_f32 v59, v59
    v_exp_f32 v60, v60
    buffer_load_dword a14, v9, s[20:23], s71 offen offset:3584
    v_exp_f32 v61, v61
    v_exp_f32 v62, v62
    buffer_load_dword a15, v9, s[20:23], s71 offen offset:3776
    v_exp_f32 v63, v63
    v_pk_add_f32 v[50:51], v[50:51], 1.0 op_sel_hi:[1,0]
    v_pk_add_f32 v[52:53], v[52:53], 1.0 op_sel_hi:[1,0]
    v_pk_add_f32 v[54:55], v[54:55], 1.0 op_sel_hi:[1,0]
    buffer_load_dword a16, v9, s[20:23], s72 offen offset:128
    v_pk_add_f32 v[56:57], v[56:57], 1.0 op_sel_hi:[1,0]
    v_pk_add_f32 v[58:59], v[58:59], 1.0 op_sel_hi:[1,0]
    v_pk_add_f32 v[60:61], v[60:61], 1.0 op_sel_hi:[1,0]
    buffer_load_dword a17, v9, s[20:23], s72 offen offset:320
    v_pk_add_f32 v[62:63], v[62:63], 1.0 op_sel_hi:[1,0]
    v_mfma_f32_32x32x16_bf16 v[18:33], a[84:87], a[60:63], v[18:33]
    v_rcp_f32 v50, v50
    v_rcp_f32 v51, v51
    v_rcp_f32 v52, v52
    v_mfma_f32_32x32x16_bf16 v[18:33], a[88:91], a[64:67], v[18:33]
    v_rcp_f32 v53, v53
    v_rcp_f32 v54, v54
    v_rcp_f32 v55, v55
    v_mfma_f32_32x32x16_bf16 v[18:33], a[92:95], a[68:71], v[18:33]
    v_rcp_f32 v56, v56
    v_rcp_f32 v57, v57
    v_rcp_f32 v58, v58
    v_rcp_f32 v59, v59
    v_rcp_f32 v60, v60
    buffer_load_dword a18, v9, s[20:23], s72 offen offset:512
    v_rcp_f32 v61, v61
    v_rcp_f32 v62, v62
    buffer_load_dword a19, v9, s[20:23], s72 offen offset:704
    v_rcp_f32 v63, v63
    v_pk_mul_f32 v[50:51], v[34:35], v[50:51]
    v_pk_mul_f32 v[52:53], v[36:37], v[52:53]
    v_pk_mul_f32 v[54:55], v[38:39], v[54:55]
    v_pk_mul_f32 v[56:57], v[40:41], v[56:57]
    v_pk_mul_f32 v[58:59], v[42:43], v[58:59]
    v_pk_mul_f32 v[60:61], v[44:45], v[60:61]
    v_pk_mul_f32 v[62:63], v[46:47], v[62:63]
    v_pk_fma_f32 v[14:15], v[50:51], v[50:51], v[14:15]
    v_cvt_pk_bf16_f32 v68, v50, v51
    v_pk_fma_f32 v[14:15], v[52:53], v[52:53], v[14:15]
    v_cvt_pk_bf16_f32 v69, v52, v53
    v_pk_fma_f32 v[14:15], v[54:55], v[54:55], v[14:15]
    v_cvt_pk_bf16_f32 v70, v54, v55
    v_pk_fma_f32 v[14:15], v[56:57], v[56:57], v[14:15]
    v_cvt_pk_bf16_f32 v71, v56, v57
    v_pk_fma_f32 v[14:15], v[58:59], v[58:59], v[14:15]
    v_cvt_pk_bf16_f32 v82, v58, v59
    v_pk_fma_f32 v[14:15], v[60:61], v[60:61], v[14:15]
    v_cvt_pk_bf16_f32 v83, v60, v61
    v_pk_fma_f32 v[14:15], v[62:63], v[62:63], v[14:15]
    v_cvt_pk_bf16_f32 v11, v62, v63
    ds_write_b32 v8, v11 offset:256
    v_pk_fma_f32 v[50:51], v[18:19], v[18:19], s[60:61]
    v_pk_fma_f32 v[52:53], v[20:21], v[20:21], s[60:61]
    buffer_load_dword a20, v9, s[20:23], s72 offen offset:3200
    v_pk_fma_f32 v[54:55], v[22:23], v[22:23], s[60:61]
    v_pk_fma_f32 v[56:57], v[24:25], v[24:25], s[60:61]
    v_pk_fma_f32 v[58:59], v[26:27], v[26:27], s[60:61]
    buffer_load_dword a21, v9, s[20:23], s72 offen offset:3392
    v_pk_fma_f32 v[60:61], v[28:29], v[28:29], s[60:61]
    v_pk_fma_f32 v[62:63], v[30:31], v[30:31], s[60:61]
    v_pk_mul_f32 v[50:51], v[18:19], v[50:51] neg_lo:[1,0] neg_hi:[1,0]
    buffer_load_dword a22, v9, s[20:23], s72 offen offset:3584
    v_pk_mul_f32 v[52:53], v[20:21], v[52:53] neg_lo:[1,0] neg_hi:[1,0]
    v_pk_mul_f32 v[54:55], v[22:23], v[54:55] neg_lo:[1,0] neg_hi:[1,0]
    v_pk_mul_f32 v[56:57], v[24:25], v[56:57] neg_lo:[1,0] neg_hi:[1,0]
    buffer_load_dword a23, v9, s[20:23], s72 offen offset:3776
    v_pk_mul_f32 v[58:59], v[26:27], v[58:59] neg_lo:[1,0] neg_hi:[1,0]
    v_pk_mul_f32 v[60:61], v[28:29], v[60:61] neg_lo:[1,0] neg_hi:[1,0]
    v_pk_mul_f32 v[62:63], v[30:31], v[62:63] neg_lo:[1,0] neg_hi:[1,0]
    v_exp_f32 v50, v50
    v_exp_f32 v51, v51
    v_exp_f32 v52, v52
    v_exp_f32 v53, v53
    v_exp_f32 v54, v54
    v_exp_f32 v55, v55
    v_exp_f32 v56, v56
    v_exp_f32 v57, v57
    v_exp_f32 v58, v58
    v_exp_f32 v59, v59
    v_exp_f32 v60, v60
    buffer_load_ushort v88, v1, s[24:27], 0 offen offset:0
    v_exp_f32 v61, v61
    v_exp_f32 v62, v62
    buffer_load_ushort v89, v1, s[24:27], 0 offen offset:64
    v_exp_f32 v63, v63
    v_pk_add_f32 v[50:51], v[50:51], 1.0 op_sel_hi:[1,0]
    v_pk_add_f32 v[52:53], v[52:53], 1.0 op_sel_hi:[1,0]
    v_pk_add_f32 v[54:55], v[54:55], 1.0 op_sel_hi:[1,0]
    buffer_load_ushort v90, v1, s[24:27], 0 offen offset:128
    v_pk_add_f32 v[56:57], v[56:57], 1.0 op_sel_hi:[1,0]
    v_pk_add_f32 v[58:59], v[58:59], 1.0 op_sel_hi:[1,0]
    v_pk_add_f32 v[60:61], v[60:61], 1.0 op_sel_hi:[1,0]
    buffer_load_ushort v91, v1, s[24:27], 0 offen offset:384
    v_pk_add_f32 v[62:63], v[62:63], 1.0 op_sel_hi:[1,0]
    v_rcp_f32 v50, v50
    v_rcp_f32 v51, v51
    v_rcp_f32 v52, v52
    v_rcp_f32 v53, v53
    v_rcp_f32 v54, v54
    v_rcp_f32 v55, v55
    v_rcp_f32 v56, v56
    v_rcp_f32 v57, v57
    v_rcp_f32 v58, v58
    v_rcp_f32 v59, v59
    v_rcp_f32 v60, v60
    buffer_load_ushort v92, v1, s[24:27], 0 offen offset:448
    v_rcp_f32 v61, v61
    v_rcp_f32 v62, v62
    buffer_load_ushort v93, v1, s[24:27], 0 offen offset:512
    v_rcp_f32 v63, v63
    v_pk_mul_f32 v[18:19], v[18:19], v[50:51]
    v_pk_mul_f32 v[20:21], v[20:21], v[52:53]
    v_pk_mul_f32 v[22:23], v[22:23], v[54:55]
    buffer_load_dwordx4 v[94:97], v0, s[8:11], 0 offen
    v_pk_mul_f32 v[24:25], v[24:25], v[56:57]
    v_pk_mul_f32 v[26:27], v[26:27], v[58:59]
    v_pk_mul_f32 v[28:29], v[28:29], v[60:61]
    v_pk_mul_f32 v[30:31], v[30:31], v[62:63]
    v_pk_fma_f32 v[50:51], v[18:19], v[18:19], 0
    v_pk_fma_f32 v[16:17], v[20:21], v[20:21], v[16:17]
    v_pk_fma_f32 v[50:51], v[22:23], v[22:23], v[50:51]
    v_pk_fma_f32 v[16:17], v[24:25], v[24:25], v[16:17]
    v_pk_fma_f32 v[50:51], v[26:27], v[26:27], v[50:51]
    v_pk_fma_f32 v[16:17], v[28:29], v[28:29], v[16:17]
    v_pk_fma_f32 v[50:51], v[30:31], v[30:31], v[50:51]
    v_pk_add_f32 v[16:17], v[16:17], v[50:51]
    s_setprio 0
    v_add_f32 v12, v12, v13
    v_add_f32 v14, v14, v15
    v_add_f32 v16, v16, v17
    v_mov_b32 v13, v16
    s_lshl_b32 s48, s44, 8
    s_add_u32 s49, s48, 15360
    v_permlane32_swap_b32 v12, v14
    v_permlane32_swap_b32 v13, v16
    v_add_f32 v12, v12, v14
    v_add_f32 v13, v13, v16
    ds_write_b32 v7, v12
    ds_write_b32 v7, v13 offset:8
    v_add_u32 v16, s49, v3
    v_add_u32 v17, 144384, v16
    s_lshl_b32 s49, s67, 11
    s_add_u32 s49, s49, s48
    v_subrev_u32 v6, 49152, v6
    s_mov_b32 s50, 0x88888888
    s_mov_b32 s51, 0x88888888
    s_waitcnt lgkmcnt(0)
    s_barrier
    ds_read_b32 v16, v16
    ds_read_b32 v17, v17
    v_lshrrev_b32 v14, 6, v2
    v_bfe_u32 v12, v2, 4, 2
    v_bfe_u32 v15, v2, 8, 1
    v_lshlrev_b32 v15, 1, v15
    v_xor_b32 v12, v12, v15
    v_lshlrev_b32 v12, 3, v12
    v_lshl_add_u32 v12, v14, 5, v12
    s_waitcnt lgkmcnt(0)
    v_add_f32 v16, v16, v17
    v_cndmask_b32 v16, v16, 1.0, s[50:51]
    buffer_atomic_add_f32 v16, v3, s[40:43], s49 offen
    v_cvt_pk_bf16_f32 v72, v18, v19
    v_cvt_pk_bf16_f32 v73, v20, v21
    v_cvt_pk_bf16_f32 v74, v22, v23
    v_cvt_pk_bf16_f32 v75, v24, v25
    v_cvt_pk_bf16_f32 v86, v26, v27
    v_cvt_pk_bf16_f32 v87, v28, v29
    v_cvt_pk_bf16_f32 v11, v30, v31
    ds_write_b32 v8, v11 offset:512
    s_waitcnt vmcnt(1)
    s_setprio 1
    ds_write_b128 v6, v[64:67] offset:0
    v_lshlrev_b32 v16, 16, v100
    v_and_b32 v100, s64, v100
    v_lshlrev_b32 v17, 16, v101
    v_and_b32 v101, s64, v101
    ds_write_b128 v6, v[68:71] offset:1024
    v_lshlrev_b32 v18, 16, v102
    v_and_b32 v102, s64, v102
    v_lshlrev_b32 v19, 16, v103
    v_and_b32 v103, s64, v103
    ds_write_b128 v6, v[72:75] offset:2048
    v_lshlrev_b32 v20, 16, v104
    v_and_b32 v104, s64, v104
    v_lshlrev_b32 v21, 16, v105
    v_and_b32 v105, s64, v105
    ds_write_b128 v5, v[76:79] offset:0
    v_lshlrev_b32 v22, 16, v106
    v_and_b32 v106, s64, v106
    v_lshlrev_b32 v23, 16, v107
    v_and_b32 v107, s64, v107
    ds_write_b128 v5, v[80:83] offset:1024
    v_lshlrev_b32 v24, 16, v108
    v_and_b32 v108, s64, v108
    v_lshlrev_b32 v25, 16, v109
    v_and_b32 v109, s64, v109
    ds_write_b128 v5, v[84:87] offset:2048
    v_lshlrev_b32 v26, 16, v110
    v_and_b32 v110, s64, v110
    v_lshlrev_b32 v27, 16, v111
    v_and_b32 v111, s64, v111
    v_lshlrev_b32 v28, 16, v112
    v_and_b32 v112, s64, v112
    v_lshlrev_b32 v29, 16, v113
    v_and_b32 v113, s64, v113
    s_waitcnt lgkmcnt(0)
    s_barrier
    v_lshlrev_b32 v30, 16, v114
    v_and_b32 v114, s64, v114
    v_lshlrev_b32 v31, 16, v115
    v_and_b32 v115, s64, v115
    v_lshlrev_b32 v32, 16, v116
    v_and_b32 v116, s64, v116
    v_lshlrev_b32 v33, 16, v117
    v_and_b32 v117, s64, v117
    v_lshlrev_b32 v34, 16, v118
    v_and_b32 v118, s64, v118
    v_lshlrev_b32 v35, 16, v119
    v_and_b32 v119, s64, v119
    v_lshlrev_b32 v36, 16, v120
    v_and_b32 v120, s64, v120
    v_lshlrev_b32 v37, 16, v121
    v_and_b32 v121, s64, v121
    v_lshlrev_b32 v38, 16, v122
    v_and_b32 v122, s64, v122
    v_lshlrev_b32 v39, 16, v123
    v_and_b32 v123, s64, v123
    v_lshlrev_b32 v40, 16, v124
    v_and_b32 v124, s64, v124
    v_lshlrev_b32 v41, 16, v125
    v_and_b32 v125, s64, v125
    v_lshlrev_b32 v42, 16, v126
    v_and_b32 v126, s64, v126
    v_lshlrev_b32 v43, 16, v127
    v_and_b32 v127, s64, v127
    v_lshlrev_b32 v44, 16, v128
    v_and_b32 v128, s64, v128
    v_lshlrev_b32 v45, 16, v129
    v_and_b32 v129, s64, v129
    v_lshlrev_b32 v46, 16, v130
    v_and_b32 v130, s64, v130
    v_lshlrev_b32 v47, 16, v131
    v_and_b32 v131, s64, v131
    v_lshlrev_b32 v48, 16, v132
    v_and_b32 v132, s64, v132
    v_lshlrev_b32 v49, 16, v133
    v_and_b32 v133, s64, v133
    v_lshlrev_b32 v50, 16, v134
    v_and_b32 v134, s64, v134
    v_lshlrev_b32 v51, 16, v135
    v_and_b32 v135, s64, v135
    v_lshlrev_b32 v52, 16, v136
    v_and_b32 v136, s64, v136
    v_lshlrev_b32 v53, 16, v137
    v_and_b32 v137, s64, v137
    v_lshlrev_b32 v54, 16, v138
    v_and_b32 v138, s64, v138
    v_lshlrev_b32 v55, 16, v139
    v_and_b32 v139, s64, v139
    v_lshlrev_b32 v56, 16, v140
    v_and_b32 v140, s64, v140
    v_lshlrev_b32 v57, 16, v141
    v_and_b32 v141, s64, v141
    v_lshlrev_b32 v58, 16, v142
    v_and_b32 v142, s64, v142
    v_lshlrev_b32 v59, 16, v143
    v_and_b32 v143, s64, v143
    v_lshlrev_b32 v60, 16, v144
    v_and_b32 v144, s64, v144
    v_lshlrev_b32 v61, 16, v145
    v_and_b32 v145, s64, v145
    v_lshlrev_b32 v62, 16, v146
    v_and_b32 v146, s64, v146
    v_lshlrev_b32 v63, 16, v147
    v_and_b32 v147, s64, v147
    v_lshrrev_b32 v6, 8, v2
    v_lshlrev_b32 v4, 3, v14
    v_add_u32 v4, 12288, v4
    s_mov_b32 s54, 0x05040100
    s_mov_b32 s55, 0x07060302
    v_accvgpr_read_b32 v76, a0
    v_accvgpr_read_b32 v77, a1
    v_accvgpr_read_b32 v78, a2
    v_accvgpr_read_b32 v79, a3
    v_lshlrev_b32 v8, 16, v148
    v_and_b32 v9, s64, v148
    v_lshlrev_b32 v10, 16, v149
    v_and_b32 v11, s64, v149
    v_perm_b32 v80, v77, v76, s54
    v_perm_b32 v81, v77, v76, s55
    v_perm_b32 v82, v79, v78, s54
    v_perm_b32 v83, v79, v78, s55
    v_pk_mul_f32 v[64:65], v[16:17], v[8:9]
    v_pk_mul_f32 v[66:67], v[100:101], v[8:9]
    v_pk_mul_f32 v[68:69], v[40:41], v[8:9]
    v_pk_mul_f32 v[70:71], v[124:125], v[8:9]
    v_dot2_f32_bf16 v72, v80, v148, 0
    v_dot2_f32_bf16 v74, v81, v148, 0
    v_pk_fma_f32 v[64:65], v[18:19], v[10:11], v[64:65]
    v_pk_fma_f32 v[66:67], v[102:103], v[10:11], v[66:67]
    v_pk_fma_f32 v[68:69], v[42:43], v[10:11], v[68:69]
    v_pk_fma_f32 v[70:71], v[126:127], v[10:11], v[70:71]
    v_dot2_f32_bf16 v72, v82, v149, v72
    v_dot2_f32_bf16 v74, v83, v149, v74
    v_accvgpr_read_b32 v76, a4
    v_accvgpr_read_b32 v77, a5
    v_accvgpr_read_b32 v78, a6
    v_accvgpr_read_b32 v79, a7
    v_lshlrev_b32 v8, 16, v150
    v_and_b32 v9, s64, v150
    v_lshlrev_b32 v10, 16, v151
    v_and_b32 v11, s64, v151
    v_perm_b32 v80, v77, v76, s54
    v_perm_b32 v81, v77, v76, s55
    v_perm_b32 v82, v79, v78, s54
    v_perm_b32 v83, v79, v78, s55
    v_pk_fma_f32 v[64:65], v[20:21], v[8:9], v[64:65]
    v_pk_fma_f32 v[66:67], v[104:105], v[8:9], v[66:67]
    v_pk_fma_f32 v[68:69], v[44:45], v[8:9], v[68:69]
    v_pk_fma_f32 v[70:71], v[128:129], v[8:9], v[70:71]
    v_dot2_f32_bf16 v72, v80, v150, v72
    v_dot2_f32_bf16 v74, v81, v150, v74
    v_pk_fma_f32 v[64:65], v[22:23], v[10:11], v[64:65]
    v_pk_fma_f32 v[66:67], v[106:107], v[10:11], v[66:67]
    v_pk_fma_f32 v[68:69], v[46:47], v[10:11], v[68:69]
    v_pk_fma_f32 v[70:71], v[130:131], v[10:11], v[70:71]
    v_dot2_f32_bf16 v72, v82, v151, v72
    v_dot2_f32_bf16 v74, v83, v151, v74
    v_accvgpr_read_b32 v76, a8
    v_accvgpr_read_b32 v77, a9
    v_accvgpr_read_b32 v78, a10
    v_accvgpr_read_b32 v79, a11
    v_lshlrev_b32 v8, 16, v152
    v_and_b32 v9, s64, v152
    v_lshlrev_b32 v10, 16, v153
    v_and_b32 v11, s64, v153
    v_perm_b32 v80, v77, v76, s54
    v_perm_b32 v81, v77, v76, s55
    v_perm_b32 v82, v79, v78, s54
    v_perm_b32 v83, v79, v78, s55
    v_pk_fma_f32 v[64:65], v[24:25], v[8:9], v[64:65]
    v_pk_fma_f32 v[66:67], v[108:109], v[8:9], v[66:67]
    v_pk_fma_f32 v[68:69], v[48:49], v[8:9], v[68:69]
    v_pk_fma_f32 v[70:71], v[132:133], v[8:9], v[70:71]
    v_dot2_f32_bf16 v72, v80, v152, v72
    v_dot2_f32_bf16 v74, v81, v152, v74
    v_pk_fma_f32 v[64:65], v[26:27], v[10:11], v[64:65]
    v_pk_fma_f32 v[66:67], v[110:111], v[10:11], v[66:67]
    v_pk_fma_f32 v[68:69], v[50:51], v[10:11], v[68:69]
    v_pk_fma_f32 v[70:71], v[134:135], v[10:11], v[70:71]
    v_dot2_f32_bf16 v72, v82, v153, v72
    v_dot2_f32_bf16 v74, v83, v153, v74
    v_accvgpr_read_b32 v76, a12
    v_accvgpr_read_b32 v77, a13
    v_accvgpr_read_b32 v78, a14
    v_accvgpr_read_b32 v79, a15
    v_lshlrev_b32 v8, 16, v154
    v_and_b32 v9, s64, v154
    v_lshlrev_b32 v10, 16, v155
    v_and_b32 v11, s64, v155
    v_perm_b32 v80, v77, v76, s54
    v_perm_b32 v81, v77, v76, s55
    v_perm_b32 v82, v79, v78, s54
    v_perm_b32 v83, v79, v78, s55
    v_pk_fma_f32 v[64:65], v[28:29], v[8:9], v[64:65]
    v_pk_fma_f32 v[66:67], v[112:113], v[8:9], v[66:67]
    v_pk_fma_f32 v[68:69], v[52:53], v[8:9], v[68:69]
    v_pk_fma_f32 v[70:71], v[136:137], v[8:9], v[70:71]
    v_dot2_f32_bf16 v72, v80, v154, v72
    v_dot2_f32_bf16 v74, v81, v154, v74
    v_pk_fma_f32 v[64:65], v[30:31], v[10:11], v[64:65]
    v_pk_fma_f32 v[66:67], v[114:115], v[10:11], v[66:67]
    v_pk_fma_f32 v[68:69], v[54:55], v[10:11], v[68:69]
    v_pk_fma_f32 v[70:71], v[138:139], v[10:11], v[70:71]
    v_dot2_f32_bf16 v72, v82, v155, v72
    v_dot2_f32_bf16 v74, v83, v155, v74
    v_accvgpr_read_b32 v76, a16
    v_accvgpr_read_b32 v77, a17
    v_accvgpr_read_b32 v78, a18
    v_accvgpr_read_b32 v79, a19
    v_lshlrev_b32 v8, 16, v156
    v_and_b32 v9, s64, v156
    v_lshlrev_b32 v10, 16, v157
    v_and_b32 v11, s64, v157
    v_perm_b32 v80, v77, v76, s54
    v_perm_b32 v81, v77, v76, s55
    v_perm_b32 v82, v79, v78, s54
    v_perm_b32 v83, v79, v78, s55
    v_pk_fma_f32 v[64:65], v[32:33], v[8:9], v[64:65]
    v_pk_fma_f32 v[66:67], v[116:117], v[8:9], v[66:67]
    v_pk_fma_f32 v[68:69], v[56:57], v[8:9], v[68:69]
    v_pk_fma_f32 v[70:71], v[140:141], v[8:9], v[70:71]
    v_dot2_f32_bf16 v72, v80, v156, v72
    v_dot2_f32_bf16 v74, v81, v156, v74
    v_pk_fma_f32 v[64:65], v[34:35], v[10:11], v[64:65]
    v_pk_fma_f32 v[66:67], v[118:119], v[10:11], v[66:67]
    v_pk_fma_f32 v[68:69], v[58:59], v[10:11], v[68:69]
    v_pk_fma_f32 v[70:71], v[142:143], v[10:11], v[70:71]
    v_dot2_f32_bf16 v72, v82, v157, v72
    v_dot2_f32_bf16 v74, v83, v157, v74
    v_accvgpr_read_b32 v76, a20
    v_accvgpr_read_b32 v77, a21
    v_accvgpr_read_b32 v78, a22
    v_accvgpr_read_b32 v79, a23
    v_lshlrev_b32 v8, 16, v158
    v_and_b32 v9, s64, v158
    v_lshlrev_b32 v10, 16, v159
    v_and_b32 v11, s64, v159
    v_perm_b32 v80, v77, v76, s54
    v_perm_b32 v81, v77, v76, s55
    v_perm_b32 v82, v79, v78, s54
    v_perm_b32 v83, v79, v78, s55
    v_pk_fma_f32 v[64:65], v[36:37], v[8:9], v[64:65]
    v_pk_fma_f32 v[66:67], v[120:121], v[8:9], v[66:67]
    v_pk_fma_f32 v[68:69], v[60:61], v[8:9], v[68:69]
    v_pk_fma_f32 v[70:71], v[144:145], v[8:9], v[70:71]
    v_dot2_f32_bf16 v72, v80, v158, v72
    v_dot2_f32_bf16 v74, v81, v158, v74
    v_pk_fma_f32 v[64:65], v[38:39], v[10:11], v[64:65]
    v_pk_fma_f32 v[66:67], v[122:123], v[10:11], v[66:67]
    v_pk_fma_f32 v[68:69], v[62:63], v[10:11], v[68:69]
    v_pk_fma_f32 v[70:71], v[146:147], v[10:11], v[70:71]
    v_dot2_f32_bf16 v72, v82, v159, v72
    v_dot2_f32_bf16 v74, v83, v159, v74
    s_cmp_lg_u32 s44, 7
    s_cbranch_scc1 L_nopoll0
    s_getreg_b32 s57, hwreg(HW_REG_XCC_ID)
    s_and_b32 s57, s57, 7
    s_lshl_b32 s57, s57, 11
    s_add_u32 s57, s57, 131072
    buffer_load_dwordx4 v[148:151], v2, s[40:43], s57 offen sc1
    buffer_load_dwordx4 v[152:155], v2, s[40:43], s57 offen offset:1024 sc1
L_nopoll0:
    v_add_f32 v64, v64, v65
    v_add_f32 v66, v66, v67
    v_add_f32 v68, v68, v69
    v_add_f32 v70, v70, v71
    s_mul_i32 s52, s45, 384
    s_add_u32 s52, s52, 18432
    v_bfe_u32 v8, v2, 4, 4
    v_lshlrev_b32 v8, 2, v8
    v_permlane32_swap_b32 v64, v66
    v_permlane32_swap_b32 v68, v70
    v_permlane32_swap_b32 v72, v74
    v_lshrrev_b32 v9, 1, v6
    v_lshlrev_b32 v9, 6, v9
    v_add3_u32 v8, v8, v9, s52
    v_add_f32 v64, v64, v66
    v_add_f32 v68, v68, v70
    v_add_f32 v72, v72, v74
    v_and_b32 v9, 1, v6
    v_mov_b32 v74, v72
    v_permlane16_swap_b32 v64, v68
    v_lshl_add_u32 v9, v9, 7, v8
    v_permlane16_swap_b32 v74, v72
    v_add_f32 v64, v64, v68
    v_add_f32 v72, v72, v74
    ds_write_b32 v9, v64
    ds_write_b32 v8, v72 offset:256
    s_setprio 0
    s_waitcnt lgkmcnt(0)
    s_barrier
    s_mul_i32 s48, s45, 384
    s_add_u32 s48, s48, 161792
    v_lshlrev_b32 v3, 4, v6
    v_add_u32 v3, s48, v3
    s_lshl_b32 s48, s45, 10
    v_add_u32 v10, s48, v2
    v_add_u32 v5, 49152, v10
    s_mul_i32 s48, s45, 24576
    v_add_u32 v7, s48, v2
    s_lshl_b32 s48, s45, 7
    s_add_u32 s48, s48, 163392
    v_lshlrev_b32 v98, 4, v6
    v_add_u32 v98, s48, v98
    s_cmp_eq_u32 s44, 7
    s_cbranch_scc1 L_b7_poll
    ds_read_b64_tr_b16 a[48:49], v4 offset:0
    ds_read_b64_tr_b16 a[50:51], v4 offset:128
    ds_read_b64_tr_b16 a[52:53], v4 offset:768
    ds_read_b64_tr_b16 a[54:55], v4 offset:896
    ds_read_b64_tr_b16 a[56:57], v4 offset:1536
    ds_read_b64_tr_b16 a[58:59], v4 offset:1664
    ds_read_b64_tr_b16 a[60:61], v4 offset:2304
    ds_read_b64_tr_b16 a[62:63], v4 offset:2432
    ds_read_b64_tr_b16 a[64:65], v4 offset:256
    ds_read_b64_tr_b16 a[66:67], v4 offset:384
    ds_read_b64_tr_b16 a[68:69], v4 offset:1024
    ds_read_b64_tr_b16 a[70:71], v4 offset:1152
    ds_read_b64_tr_b16 a[72:73], v4 offset:1792
    ds_read_b64_tr_b16 a[74:75], v4 offset:1920
    ds_read_b64_tr_b16 a[76:77], v4 offset:2560
    ds_read_b64_tr_b16 a[78:79], v4 offset:2688
    ds_read_b64_tr_b16 a[80:81], v4 offset:512
    ds_read_b64_tr_b16 a[82:83], v4 offset:640
    ds_read_b64_tr_b16 a[84:85], v4 offset:1280
    ds_read_b64_tr_b16 a[86:87], v4 offset:1408
    ds_read_b64_tr_b16 a[88:89], v4 offset:2048
    ds_read_b64_tr_b16 a[90:91], v4 offset:2176
    ds_read_b64_tr_b16 a[92:93], v4 offset:2816
    ds_read_b64_tr_b16 a[94:95], v4 offset:2944
    s_waitcnt lgkmcnt(0)
    s_branch L_b_ready
L_b7_poll:
    v_lshlrev_b32 v88, 16, v88
    v_lshlrev_b32 v89, 16, v89
    v_lshlrev_b32 v90, 16, v90
    v_lshlrev_b32 v91, 16, v91
    v_lshlrev_b32 v92, 16, v92
    v_lshlrev_b32 v93, 16, v93
    v_mul_f32 v88, 1074302617, v88
    v_mul_f32 v89, 1074302617, v89
    v_mul_f32 v90, 1074302617, v90
    v_mul_f32 v91, 1074302617, v91
    v_mul_f32 v92, 1074302617, v92
    v_mul_f32 v93, 1074302617, v93
    v_and_b32 v9, 0xf0, v2
    v_lshrrev_b32 v9, 2, v9
    v_mul_u32_u24 v8, 192, v6
    v_add_u32 v8, 161792, v8
    v_add_u32 v8, v8, v9
    v_mov_b32 v9, 992651947
    v_mov_b32 v4, 897988541
    v_mov_b32 v11, 1074302617
    s_mov_b32 s75, 0
L_poll:
    s_waitcnt vmcnt(0)
    v_min_f32 v72, v151, v155
    v_cmp_gt_f32 vcc, 1.0, v72
    s_cbranch_vccz L_poll_ok
    s_add_u32 s75, s75, 1
    s_cmp_ge_u32 s75, 100000
    s_cbranch_scc1 L_poll_ok
    s_sleep 1
    buffer_load_dwordx4 v[148:151], v2, s[40:43], s57 offen sc1
    buffer_load_dwordx4 v[152:155], v2, s[40:43], s57 offen offset:1024 sc1
    s_branch L_poll
L_poll_ok:
    v_pk_add_f32 v[72:73], v[148:149], v[152:153]
    v_add_f32 v74, v150, v154
    v_add_f32 v72, v72, v73
    v_add_f32 v72, v72, v74
    v_mul_f32 v88, v88, v148
    s_nop 0
    v_add_f32_dpp v72, v72, v72 row_shr:1 bound_ctrl:0
    v_mul_f32 v89, v89, v149
    s_nop 0
    v_add_f32_dpp v72, v72, v72 row_shr:2 bound_ctrl:0
    v_mul_f32 v90, v90, v150
    s_nop 0
    v_add_f32_dpp v72, v72, v72 row_shr:4 bound_ctrl:0
    v_mul_f32 v91, v91, v152
    s_nop 0
    v_add_f32_dpp v72, v72, v72 row_shr:8 bound_ctrl:0
    v_mul_f32 v92, v92, v153
    s_nop 0
    v_add_f32_dpp v72, v72, v72 row_bcast:15 row_mask:0xa
    v_mul_f32 v93, v93, v154
    s_nop 0
    v_add_f32_dpp v72, v72, v72 row_bcast:31 row_mask:0xc
    s_nop 0
    v_readlane_b32 s53, v72, 63
    s_nop 1
    v_fma_f32 v72, s53, v9, v4
    v_rcp_f32 v72, v72
    s_nop 0
    v_fma_f32 v88, v88, v72, v11
    v_fma_f32 v89, v89, v72, v11
    v_fma_f32 v90, v90, v72, v11
    v_fma_f32 v91, v91, v72, v11
    v_fma_f32 v92, v92, v72, v11
    v_fma_f32 v93, v93, v72, v11
    ds_write_b32 v8, v88 offset:0
    ds_write_b32 v8, v89 offset:64
    ds_write_b32 v8, v90 offset:128
    ds_write_b32 v8, v91 offset:768
    ds_write_b32 v8, v92 offset:832
    ds_write_b32 v8, v93 offset:896
    s_waitcnt lgkmcnt(0)
L_b_ready:
    s_barrier
    s_setprio 2
    ds_read_b128 v[64:67], v3 offset:0
    ds_read_b128 v[68:71], v3 offset:192
    ds_read_b128 v[72:75], v3 offset:64
    ds_read_b128 v[76:79], v3 offset:256
    ds_read_b128 v[80:83], v3 offset:128
    ds_read_b128 v[84:87], v3 offset:320
    s_waitcnt lgkmcnt(5)
    v_pk_mul_f32 v[16:17], v[16:17], v[64:65]
    v_pk_mul_f32 v[18:19], v[18:19], v[66:67]
    s_waitcnt lgkmcnt(4)
    v_pk_mul_f32 v[20:21], v[20:21], v[68:69]
    v_pk_mul_f32 v[22:23], v[22:23], v[70:71]
    v_cvt_pk_bf16_f32 v16, v16, v17
    v_cvt_pk_bf16_f32 v17, v18, v19
    v_cvt_pk_bf16_f32 v18, v20, v21
    v_cvt_pk_bf16_f32 v19, v22, v23
    v_pk_mul_f32 v[100:101], v[100:101], v[64:65]
    v_pk_mul_f32 v[102:103], v[102:103], v[66:67]
    v_pk_mul_f32 v[104:105], v[104:105], v[68:69]
    v_pk_mul_f32 v[106:107], v[106:107], v[70:71]
    ds_write_b128 v10, v[16:19] offset:0
    v_cvt_pk_bf16_f32 v100, v100, v101
    v_cvt_pk_bf16_f32 v101, v102, v103
    v_cvt_pk_bf16_f32 v102, v104, v105
    v_cvt_pk_bf16_f32 v103, v106, v107
    s_waitcnt lgkmcnt(4)
    v_pk_mul_f32 v[24:25], v[24:25], v[72:73]
    v_pk_mul_f32 v[26:27], v[26:27], v[74:75]
    s_waitcnt lgkmcnt(3)
    v_pk_mul_f32 v[28:29], v[28:29], v[76:77]
    v_pk_mul_f32 v[30:31], v[30:31], v[78:79]
    ds_write_b128 v10, v[100:103] offset:12288
    v_cvt_pk_bf16_f32 v24, v24, v25
    v_cvt_pk_bf16_f32 v25, v26, v27
    v_cvt_pk_bf16_f32 v26, v28, v29
    v_cvt_pk_bf16_f32 v27, v30, v31
    v_pk_mul_f32 v[108:109], v[108:109], v[72:73]
    v_pk_mul_f32 v[110:111], v[110:111], v[74:75]
    v_pk_mul_f32 v[112:113], v[112:113], v[76:77]
    v_pk_mul_f32 v[114:115], v[114:115], v[78:79]
    ds_write_b128 v10, v[24:27] offset:4096
    v_cvt_pk_bf16_f32 v108, v108, v109
    v_cvt_pk_bf16_f32 v109, v110, v111
    v_cvt_pk_bf16_f32 v110, v112, v113
    v_cvt_pk_bf16_f32 v111, v114, v115
    s_waitcnt lgkmcnt(4)
    v_pk_mul_f32 v[32:33], v[32:33], v[80:81]
    v_pk_mul_f32 v[34:35], v[34:35], v[82:83]
    s_waitcnt lgkmcnt(3)
    v_pk_mul_f32 v[36:37], v[36:37], v[84:85]
    v_pk_mul_f32 v[38:39], v[38:39], v[86:87]
    ds_write_b128 v10, v[108:111] offset:16384
    v_cvt_pk_bf16_f32 v32, v32, v33
    v_cvt_pk_bf16_f32 v33, v34, v35
    v_cvt_pk_bf16_f32 v34, v36, v37
    v_cvt_pk_bf16_f32 v35, v38, v39
    v_pk_mul_f32 v[116:117], v[116:117], v[80:81]
    v_pk_mul_f32 v[118:119], v[118:119], v[82:83]
    v_pk_mul_f32 v[120:121], v[120:121], v[84:85]
    v_pk_mul_f32 v[122:123], v[122:123], v[86:87]
    ds_write_b128 v10, v[32:35] offset:8192
    v_cvt_pk_bf16_f32 v116, v116, v117
    v_cvt_pk_bf16_f32 v117, v118, v119
    v_cvt_pk_bf16_f32 v118, v120, v121
    v_cvt_pk_bf16_f32 v119, v122, v123
    ds_write_b128 v10, v[116:119] offset:20480
    s_setprio 0
    s_waitcnt lgkmcnt(0)
    s_barrier
    v_mul_f32 v40, v40, v64
    v_mul_f32 v41, v41, v65
    v_mul_f32 v42, v42, v66
    v_mul_f32 v43, v43, v67
    v_mul_f32 v44, v44, v68
    v_mul_f32 v45, v45, v69
    v_mul_f32 v46, v46, v70
    v_mul_f32 v47, v47, v71
    v_cvt_pk_bf16_f32 v40, v40, v41
    v_cvt_pk_bf16_f32 v41, v42, v43
    v_cvt_pk_bf16_f32 v42, v44, v45
    v_cvt_pk_bf16_f32 v43, v46, v47
    v_mul_f32 v124, v124, v64
    v_mul_f32 v125, v125, v65
    v_mul_f32 v126, v126, v66
    v_mul_f32 v127, v127, v67
    v_mul_f32 v128, v128, v68
    v_mul_f32 v129, v129, v69
    v_mul_f32 v130, v130, v70
    v_mul_f32 v131, v131, v71
    ds_write_b128 v10, v[40:43] offset:24576
    v_cvt_pk_bf16_f32 v124, v124, v125
    v_cvt_pk_bf16_f32 v125, v126, v127
    v_cvt_pk_bf16_f32 v126, v128, v129
    v_cvt_pk_bf16_f32 v127, v130, v131
    v_mul_f32 v48, v48, v72
    v_mul_f32 v49, v49, v73
    v_mul_f32 v50, v50, v74
    v_mul_f32 v51, v51, v75
    v_mul_f32 v52, v52, v76
    v_mul_f32 v53, v53, v77
    v_mul_f32 v54, v54, v78
    v_mul_f32 v55, v55, v79
    ds_write_b128 v10, v[124:127] offset:36864
    v_cvt_pk_bf16_f32 v48, v48, v49
    v_cvt_pk_bf16_f32 v49, v50, v51
    v_cvt_pk_bf16_f32 v50, v52, v53
    v_cvt_pk_bf16_f32 v51, v54, v55
    v_mul_f32 v132, v132, v72
    v_mul_f32 v133, v133, v73
    v_mul_f32 v134, v134, v74
    v_mul_f32 v135, v135, v75
    v_mul_f32 v136, v136, v76
    v_mul_f32 v137, v137, v77
    v_mul_f32 v138, v138, v78
    v_mul_f32 v139, v139, v79
    ds_write_b128 v10, v[48:51] offset:28672
    v_cvt_pk_bf16_f32 v132, v132, v133
    v_cvt_pk_bf16_f32 v133, v134, v135
    v_cvt_pk_bf16_f32 v134, v136, v137
    v_cvt_pk_bf16_f32 v135, v138, v139
    v_mul_f32 v56, v56, v80
    v_mul_f32 v57, v57, v81
    v_mul_f32 v58, v58, v82
    v_mul_f32 v59, v59, v83
    v_mul_f32 v60, v60, v84
    v_mul_f32 v61, v61, v85
    v_mul_f32 v62, v62, v86
    v_mul_f32 v63, v63, v87
    ds_write_b128 v10, v[132:135] offset:40960
    v_cvt_pk_bf16_f32 v56, v56, v57
    v_cvt_pk_bf16_f32 v57, v58, v59
    v_cvt_pk_bf16_f32 v58, v60, v61
    v_cvt_pk_bf16_f32 v59, v62, v63
    v_mul_f32 v140, v140, v80
    v_mul_f32 v141, v141, v81
    v_mul_f32 v142, v142, v82
    v_mul_f32 v143, v143, v83
    v_mul_f32 v144, v144, v84
    v_mul_f32 v145, v145, v85
    v_mul_f32 v146, v146, v86
    v_mul_f32 v147, v147, v87
    ds_write_b128 v10, v[56:59] offset:32768
    v_cvt_pk_bf16_f32 v140, v140, v141
    v_cvt_pk_bf16_f32 v141, v142, v143
    v_cvt_pk_bf16_f32 v142, v144, v145
    v_cvt_pk_bf16_f32 v143, v146, v147
    ds_write_b128 v10, v[140:143] offset:45056
    v_accvgpr_read_b32 v100, a0
    v_accvgpr_read_b32 v101, a1
    v_accvgpr_read_b32 v102, a2
    v_accvgpr_read_b32 v103, a3
    v_accvgpr_read_b32 v104, a4
    v_accvgpr_read_b32 v105, a5
    v_accvgpr_read_b32 v106, a6
    v_accvgpr_read_b32 v107, a7
    v_accvgpr_read_b32 v108, a8
    v_accvgpr_read_b32 v109, a9
    v_accvgpr_read_b32 v110, a10
    v_accvgpr_read_b32 v111, a11
    v_accvgpr_read_b32 v112, a12
    v_accvgpr_read_b32 v113, a13
    v_accvgpr_read_b32 v114, a14
    v_accvgpr_read_b32 v115, a15
    v_accvgpr_read_b32 v116, a16
    v_accvgpr_read_b32 v117, a17
    v_accvgpr_read_b32 v118, a18
    v_accvgpr_read_b32 v119, a19
    v_accvgpr_read_b32 v120, a20
    v_accvgpr_read_b32 v121, a21
    v_accvgpr_read_b32 v122, a22
    v_accvgpr_read_b32 v123, a23
    v_lshlrev_b32 v16, 16, v100
    v_and_b32 v100, s64, v100
    v_lshlrev_b32 v17, 16, v101
    v_and_b32 v101, s64, v101
    v_lshlrev_b32 v18, 16, v102
    v_and_b32 v102, s64, v102
    s_waitcnt lgkmcnt(0)
    s_barrier
    v_lshlrev_b32 v19, 16, v103
    v_and_b32 v103, s64, v103
    v_lshlrev_b32 v20, 16, v104
    v_and_b32 v104, s64, v104
    v_lshlrev_b32 v21, 16, v105
    v_and_b32 v105, s64, v105
    v_lshlrev_b32 v22, 16, v106
    v_and_b32 v106, s64, v106
    v_lshlrev_b32 v23, 16, v107
    v_and_b32 v107, s64, v107
    v_lshlrev_b32 v24, 16, v108
    v_and_b32 v108, s64, v108
    v_lshlrev_b32 v25, 16, v109
    v_and_b32 v109, s64, v109
    v_lshlrev_b32 v26, 16, v110
    v_and_b32 v110, s64, v110
    v_lshlrev_b32 v27, 16, v111
    v_and_b32 v111, s64, v111
    v_lshlrev_b32 v28, 16, v112
    v_and_b32 v112, s64, v112
    v_lshlrev_b32 v29, 16, v113
    v_and_b32 v113, s64, v113
    v_lshlrev_b32 v30, 16, v114
    v_and_b32 v114, s64, v114
    v_lshlrev_b32 v31, 16, v115
    v_and_b32 v115, s64, v115
    v_lshlrev_b32 v32, 16, v116
    v_and_b32 v116, s64, v116
    v_lshlrev_b32 v33, 16, v117
    v_and_b32 v117, s64, v117
    v_lshlrev_b32 v34, 16, v118
    v_and_b32 v118, s64, v118
    v_lshlrev_b32 v35, 16, v119
    v_and_b32 v119, s64, v119
    v_lshlrev_b32 v36, 16, v120
    v_and_b32 v120, s64, v120
    v_lshlrev_b32 v37, 16, v121
    v_and_b32 v121, s64, v121
    v_lshlrev_b32 v38, 16, v122
    v_and_b32 v122, s64, v122
    v_lshlrev_b32 v39, 16, v123
    v_and_b32 v123, s64, v123
    v_mul_f32 v16, v16, v64
    v_mul_f32 v17, v17, v65
    v_mul_f32 v18, v18, v66
    v_mul_f32 v19, v19, v67
    v_mul_f32 v20, v20, v68
    v_mul_f32 v21, v21, v69
    v_mul_f32 v22, v22, v70
    v_mul_f32 v23, v23, v71
    v_cvt_pk_bf16_f32 v16, v16, v17
    v_cvt_pk_bf16_f32 v17, v18, v19
    v_cvt_pk_bf16_f32 v18, v20, v21
    v_cvt_pk_bf16_f32 v19, v22, v23
    v_mul_f32 v100, v100, v64
    v_mul_f32 v101, v101, v65
    v_mul_f32 v102, v102, v66
    v_mul_f32 v103, v103, v67
    v_mul_f32 v104, v104, v68
    v_mul_f32 v105, v105, v69
    v_mul_f32 v106, v106, v70
    v_mul_f32 v107, v107, v71
    ds_write_b128 v5, v[16:19] offset:0
    v_cvt_pk_bf16_f32 v100, v100, v101
    v_cvt_pk_bf16_f32 v101, v102, v103
    v_cvt_pk_bf16_f32 v102, v104, v105
    v_cvt_pk_bf16_f32 v103, v106, v107
    v_mul_f32 v24, v24, v72
    v_mul_f32 v25, v25, v73
    v_mul_f32 v26, v26, v74
    v_mul_f32 v27, v27, v75
    v_mul_f32 v28, v28, v76
    v_mul_f32 v29, v29, v77
    v_mul_f32 v30, v30, v78
    v_mul_f32 v31, v31, v79
    ds_write_b128 v5, v[100:103] offset:12288
    v_cvt_pk_bf16_f32 v24, v24, v25
    v_cvt_pk_bf16_f32 v25, v26, v27
    v_cvt_pk_bf16_f32 v26, v28, v29
    v_cvt_pk_bf16_f32 v27, v30, v31
    v_mul_f32 v108, v108, v72
    v_mul_f32 v109, v109, v73
    v_mul_f32 v110, v110, v74
    v_mul_f32 v111, v111, v75
    v_mul_f32 v112, v112, v76
    v_mul_f32 v113, v113, v77
    v_mul_f32 v114, v114, v78
    v_mul_f32 v115, v115, v79
    ds_write_b128 v5, v[24:27] offset:4096
    v_cvt_pk_bf16_f32 v108, v108, v109
    v_cvt_pk_bf16_f32 v109, v110, v111
    v_cvt_pk_bf16_f32 v110, v112, v113
    v_cvt_pk_bf16_f32 v111, v114, v115
    v_mul_f32 v32, v32, v80
    v_mul_f32 v33, v33, v81
    v_mul_f32 v34, v34, v82
    v_mul_f32 v35, v35, v83
    v_mul_f32 v36, v36, v84
    v_mul_f32 v37, v37, v85
    v_mul_f32 v38, v38, v86
    v_mul_f32 v39, v39, v87
    ds_write_b128 v5, v[108:111] offset:16384
    v_cvt_pk_bf16_f32 v32, v32, v33
    v_cvt_pk_bf16_f32 v33, v34, v35
    v_cvt_pk_bf16_f32 v34, v36, v37
    v_cvt_pk_bf16_f32 v35, v38, v39
    v_mul_f32 v116, v116, v80
    v_mul_f32 v117, v117, v81
    v_mul_f32 v118, v118, v82
    v_mul_f32 v119, v119, v83
    v_mul_f32 v120, v120, v84
    v_mul_f32 v121, v121, v85
    v_mul_f32 v122, v122, v86
    v_mul_f32 v123, v123, v87
    ds_write_b128 v5, v[32:35] offset:8192
    v_cvt_pk_bf16_f32 v116, v116, v117
    v_cvt_pk_bf16_f32 v117, v118, v119
    v_cvt_pk_bf16_f32 v118, v120, v121
    v_cvt_pk_bf16_f32 v119, v122, v123
    ds_write_b128 v5, v[116:119] offset:20480
    s_waitcnt lgkmcnt(0)
    s_barrier
    s_cmp_eq_u32 s45, 3
    s_cbranch_scc1 L_done
    ds_read_b128 v[64:67], v98 offset:0
    ds_read_b128 v[68:71], v98 offset:64
    ds_read_b128 v[40:43], v7 offset:0
    ds_read_b128 v[124:127], v7 offset:12288
    ds_read_b128 v[44:47], v7 offset:1024
    ds_read_b128 v[128:131], v7 offset:13312
    ds_read_b128 v[48:51], v7 offset:2048
    ds_read_b128 v[132:135], v7 offset:14336
    ds_read_b128 v[52:55], v7 offset:3072
    ds_read_b128 v[136:139], v7 offset:15360
    ds_read_b128 v[56:59], v7 offset:4096
    ds_read_b128 v[140:143], v7 offset:16384
    ds_read_b128 v[60:63], v7 offset:5120
    ds_read_b128 v[144:147], v7 offset:17408
    v_lshlrev_b32 v12, 16, v94
    v_and_b32 v94, s64, v94
    v_lshlrev_b32 v13, 16, v95
    v_and_b32 v95, s64, v95
    v_lshlrev_b32 v14, 16, v96
    v_and_b32 v96, s64, v96
    v_lshlrev_b32 v15, 16, v97
    v_and_b32 v97, s64, v97
    s_waitcnt lgkmcnt(13)
    v_add_f32 v12, v12, v64
    s_waitcnt lgkmcnt(12)
    v_add_f32 v94, v94, v68
    v_add_f32 v13, v13, v65
    v_add_f32 v95, v95, v69
    v_add_f32 v14, v14, v66
    v_add_f32 v96, v96, v70
    v_add_f32 v15, v15, v67
    v_add_f32 v97, v97, v71
    s_waitcnt lgkmcnt(11)
    v_mfma_f32_16x16x32_bf16 v[12:15], v[40:43], a[48:51], v[12:15]
    s_waitcnt lgkmcnt(10)
    v_mfma_f32_16x16x32_bf16 v[94:97], v[124:127], a[48:51], v[94:97]
    ds_read_b128 v[40:43], v7 offset:6144
    ds_read_b128 v[124:127], v7 offset:18432
    s_waitcnt lgkmcnt(11)
    v_mfma_f32_16x16x32_bf16 v[12:15], v[44:47], a[52:55], v[12:15]
    s_waitcnt lgkmcnt(10)
    v_mfma_f32_16x16x32_bf16 v[94:97], v[128:131], a[52:55], v[94:97]
    ds_read_b128 v[44:47], v7 offset:7168
    ds_read_b128 v[128:131], v7 offset:19456
    s_waitcnt lgkmcnt(11)
    v_mfma_f32_16x16x32_bf16 v[12:15], v[48:51], a[56:59], v[12:15]
    s_waitcnt lgkmcnt(10)
    v_mfma_f32_16x16x32_bf16 v[94:97], v[132:135], a[56:59], v[94:97]
    ds_read_b128 v[48:51], v7 offset:8192
    ds_read_b128 v[132:135], v7 offset:20480
    s_waitcnt lgkmcnt(11)
    v_mfma_f32_16x16x32_bf16 v[12:15], v[52:55], a[60:63], v[12:15]
    s_waitcnt lgkmcnt(10)
    v_mfma_f32_16x16x32_bf16 v[94:97], v[136:139], a[60:63], v[94:97]
    ds_read_b128 v[52:55], v7 offset:9216
    ds_read_b128 v[136:139], v7 offset:21504
    s_waitcnt lgkmcnt(11)
    v_mfma_f32_16x16x32_bf16 v[12:15], v[56:59], a[64:67], v[12:15]
    s_waitcnt lgkmcnt(10)
    v_mfma_f32_16x16x32_bf16 v[94:97], v[140:143], a[64:67], v[94:97]
    ds_read_b128 v[56:59], v7 offset:10240
    ds_read_b128 v[140:143], v7 offset:22528
    s_waitcnt lgkmcnt(11)
    v_mfma_f32_16x16x32_bf16 v[12:15], v[60:63], a[68:71], v[12:15]
    s_waitcnt lgkmcnt(10)
    v_mfma_f32_16x16x32_bf16 v[94:97], v[144:147], a[68:71], v[94:97]
    ds_read_b128 v[60:63], v7 offset:11264
    ds_read_b128 v[144:147], v7 offset:23552
    s_waitcnt lgkmcnt(11)
    v_mfma_f32_16x16x32_bf16 v[12:15], v[40:43], a[72:75], v[12:15]
    s_waitcnt lgkmcnt(10)
    v_mfma_f32_16x16x32_bf16 v[94:97], v[124:127], a[72:75], v[94:97]
    s_waitcnt lgkmcnt(9)
    v_mfma_f32_16x16x32_bf16 v[12:15], v[44:47], a[76:79], v[12:15]
    s_waitcnt lgkmcnt(8)
    v_mfma_f32_16x16x32_bf16 v[94:97], v[128:131], a[76:79], v[94:97]
    s_waitcnt lgkmcnt(7)
    v_mfma_f32_16x16x32_bf16 v[12:15], v[48:51], a[80:83], v[12:15]
    s_waitcnt lgkmcnt(6)
    v_mfma_f32_16x16x32_bf16 v[94:97], v[132:135], a[80:83], v[94:97]
    s_waitcnt lgkmcnt(5)
    v_mfma_f32_16x16x32_bf16 v[12:15], v[52:55], a[84:87], v[12:15]
    s_waitcnt lgkmcnt(4)
    v_mfma_f32_16x16x32_bf16 v[94:97], v[136:139], a[84:87], v[94:97]
    s_waitcnt lgkmcnt(3)
    v_mfma_f32_16x16x32_bf16 v[12:15], v[56:59], a[88:91], v[12:15]
    s_waitcnt lgkmcnt(2)
    v_mfma_f32_16x16x32_bf16 v[94:97], v[140:143], a[88:91], v[94:97]
    s_waitcnt lgkmcnt(1)
    v_mfma_f32_16x16x32_bf16 v[12:15], v[60:63], a[92:95], v[12:15]
    s_waitcnt lgkmcnt(0)
    v_mfma_f32_16x16x32_bf16 v[94:97], v[144:147], a[92:95], v[94:97]
    s_nop 7
    v_cvt_pk_bf16_f32 v12, v12, v94
    v_cvt_pk_bf16_f32 v13, v13, v95
    v_cvt_pk_bf16_f32 v14, v14, v96
    v_cvt_pk_bf16_f32 v15, v15, v97
    buffer_store_dwordx4 v[12:15], v0, s[32:35], 0 offen offset:0 sc1 nt
L_done:
L_exit:
    s_endpgm
.section .rodata,"a"
.p2align 6
.amdhsa_kernel standalone__modern_conv_block_slak__vision_kernel
  .amdhsa_next_free_vgpr 256
  .amdhsa_next_free_sgpr 102
  .amdhsa_accum_offset 160
  .amdhsa_group_segment_fixed_size 0
  .amdhsa_float_denorm_mode_32 3
  .amdhsa_kernarg_size 72
  .amdhsa_user_sgpr_count 2
  .amdhsa_user_sgpr_kernarg_segment_ptr 1
  .amdhsa_system_sgpr_workgroup_id_x 1
.end_amdhsa_kernel
```
